```python
import torch

def _softmax(x, axis=-1):
    return torch.softmax(x, dim=axis)
def _gelu(x):
    return torch.nn.functional.gelu(x, approximate="tanh")
def _silu(x):
    return torch.nn.functional.silu(x)
def _sigmoid(x):
    return torch.sigmoid(x)
def _layernorm(x, axis=-1, eps=1e-5):
    m = x.mean(dim=axis, keepdim=True)
    v = x.var(dim=axis, keepdim=True, unbiased=False)
    return (x - m) / torch.sqrt(v + eps)
def _scatter_add(tgt, idx, src, axis=0):
    return tgt.clone().index_add_(axis, idx, src)
def _segment_sum(src, seg, n):
    out = torch.zeros((n,) + src.shape[1:], dtype=src.dtype)
    return out.index_add_(0, seg, src)
def _pad(x, pw):
    flat = tuple(v for pair in reversed(pw) for v in pair)
    return torch.nn.functional.pad(x, flat)

kernel_name = 'sequential_preLN__linear_attn_block__swiglu_ffn__prompt'

def setup_inputs():

    _w = (lambda a: (lambda t: t.to(torch.bfloat16) if t.is_floating_point() else t)(torch.as_tensor(a)))
    def _A_setup():
        B, S, D = 1, 2048, 512
        return {
            "x": _w((lambda *s: torch.randn(*s, dtype=torch.bfloat16) * 0.05)(B, S, D)),
            "wqkv": _w((lambda *s: torch.randn(*s, dtype=torch.bfloat16) * 0.05)(D, 3 * D)),
            "wo": _w((lambda *s: torch.randn(*s, dtype=torch.bfloat16) * 0.05)(D, D)),
        }
    _A_in = _A_setup()

    def _B_setup():
        B, S, D, F = 1, 2048, 512, 1792
        return {
            "x": _w((lambda *s: torch.randn(*s, dtype=torch.bfloat16) * 0.05)(B, S, D)),
            "w_gate": _w((lambda *s: torch.randn(*s, dtype=torch.bfloat16) * 0.05)(D, F)),
            "w_up": _w((lambda *s: torch.randn(*s, dtype=torch.bfloat16) * 0.05)(D, F)),
            "w_down": _w((lambda *s: torch.randn(*s, dtype=torch.bfloat16) * 0.05)(F, D)),
        }
    _B_in = _B_setup()

    return {
        "A_x": _A_in["x"],
        "A_wqkv": _A_in["wqkv"],
        "A_wo": _A_in["wo"],
        "B_x": _B_in["x"],
        "B_w_gate": _B_in["w_gate"],
        "B_w_up": _B_in["w_up"],
        "B_w_down": _B_in["w_down"],
    }

def reference(A_x, A_wqkv, A_wo, B_x, B_w_gate, B_w_up, B_w_down):
    def _A_ref(x, wqkv, wo):
        B, S, D = x.shape
        H = 32; Dh = D // H
        qkv = (lambda x, *d: x.permute(*d))((x @ wqkv).reshape(B, S, 3, H, Dh), 2, 0, 3, 1, 4)
        q, k, v = qkv[0], qkv[1], qkv[2]
        phi = lambda t: torch.where(t > 0, t + 1, torch.exp(t)) + 1e-6
        pq, pk = phi(q), phi(k)
        kv = torch.einsum("bhsd,bhse->bhde", pk, v)
        z = torch.einsum("bhsd->bhd", pk)
        num = torch.einsum("bhqd,bhde->bhqe", pq, kv)
        den = torch.einsum("bhqd,bhd->bhq", pq, z)[..., None] + 1e-6
        o = num / den
        return (lambda x, *d: x.permute(*d))(o, 0, 2, 1, 3).reshape(B, S, D) @ wo

    def _B_ref(x, w_gate, w_up, w_down):
        g = _silu(x @ w_gate)
        u = x @ w_up
        return (g * u) @ w_down

    x = A_x
    h = x + _A_ref(_layernorm(x, axis=-1), A_wqkv, A_wo)
    h2 = h + _B_ref(_layernorm(h, axis=-1), B_w_gate, B_w_up, B_w_down)
    return h2
```

```asm
; @launch kernel=qkv_kernel grid=(256,1,1) block=(512,1,1) lds=155648
; @launch kernel=bcd_kernel grid=(256,1,1) block=(256,1,1) lds=163840
.amdgcn_target "amdgcn-amd-amdhsa--gfx950"
.text
.globl qkv_kernel
.p2align 8
.type qkv_kernel,@function
qkv_kernel:
    s_cmp_ge_u32 s2, 256
    s_cbranch_scc1 L_a_end
    s_load_dwordx2 s[4:5], s[0:1], 0
    s_load_dwordx2 s[8:9], s[0:1], 8
    s_load_dwordx2 s[12:13], s[0:1], 72
    s_load_dwordx2 s[24:25], s[0:1], 64
    s_mov_b32 s6, 0x200000
    s_mov_b32 s7, 0x00020000
    s_mov_b32 s10, 0x180000
    s_mov_b32 s11, 0x00020000
    s_mov_b32 s14, 0x1540000
    s_mov_b32 s15, 0x00020000
    s_mov_b32 s26, 0x100
    s_mov_b32 s27, 0x00020000
    s_load_dwordx2 s[40:41], s[0:1], 16
    s_load_dwordx4 s[44:47], s[0:1], 32
    s_load_dwordx2 s[42:43], s[0:1], 48
    v_and_b32 v1, 63, v0
    v_lshrrev_b32 v2, 6, v0
    s_nop 0
    v_readfirstlane_b32 s27, v2
    s_nop 0
    s_mov_b32 s39, s27
    s_mov_b32 s27, 0x00020000
    s_and_b32 s28, s39, 3
    s_and_b32 s34, s2, 7
    s_lshr_b32 s35, s2, 3
    s_and_b32 s32, s34, 3
    s_lshl_b32 s32, s32, 3
    s_and_b32 s36, s35, 7
    s_add_u32 s32, s32, s36
    s_lshr_b32 s33, s34, 2
    s_lshl_b32 s33, s33, 2
    s_lshr_b32 s36, s35, 3
    s_add_u32 s33, s33, s36
    s_and_b32 s29, s28, 1
    s_lshr_b32 s30, s28, 1
    s_xor_b32 s31, s29, s30
    s_mov_b32 s70, 0x3f803f80
    s_mov_b32 s81, 0x358637bd
    s_cmp_ge_u32 s39, 4
    s_cbranch_scc1 L_a_q
    s_lshl_b32 s38, s2, 2
    s_add_u32 s38, s38, s28
    s_mov_b32 s19, 0x00020000
    s_mov_b32 s23, 0x00020000
    s_getpc_b64 s[34:35]
L_a_pc:
    s_sub_u32 s34, s34, L_a_pc-qkv_kernel
    s_subb_u32 s35, s35, 0
    s_lshr_b32 s36, s2, 3
    s_lshl_b32 s36, s36, 2
    s_add_u32 s36, s36, s28
    s_lshl_b32 s36, s36, 10
    v_lshlrev_b32 v8, 4, v1
    v_add_u32 v8, s36, v8
    v_min_u32 v8, L_text_end-qkv_kernel-4, v8
    global_load_dword v239, v8, s[34:35]
    s_waitcnt lgkmcnt(0)
    s_cmp_ge_u32 s38, 448
    s_cbranch_scc1 L_a_pstd
    s_mov_b32 s48, 0x924924a
    s_mul_hi_u32 s37, s38, s48
    s_mul_i32 s48, s37, 28
    s_sub_u32 s69, s38, s48
    s_mov_b32 s16, s44
    s_mov_b32 s17, s45
    s_mov_b32 s18, 0x1c0000
    s_mov_b32 s20, s46
    s_mov_b32 s21, s47
    s_mov_b32 s22, 0x1c0000
    s_movk_i32 s50, 3584
    s_mul_i32 s48, s37, 114688
    s_lshl_b32 s49, s69, 7
    s_add_u32 s48, s48, s49
    s_mov_b32 s49, s48
    s_lshl_b32 s59, s69, 7
    s_lshl_b32 s51, s37, 1
    s_add_u32 s59, s59, s51
    s_lshl_b32 s59, s59, 10
    s_add_u32 s72, s59, 0x810000
    s_mov_b32 s73, 32768
    s_mov_b32 s74, 65536
    s_mov_b32 s75, 1024
    s_mul_i32 s59, s37, 14336
    s_lshl_b32 s69, s69, 9
    s_add_u32 s59, s59, s69
    s_add_u32 s59, s59, 0xb90000
    s_mov_b32 s68, 1
    s_branch L_a_pgo
L_a_pstd:
    s_movk_i32 s50, 1024
    s_mov_b32 s68, 0
    s_mov_b32 s59, 0x7fff0000
    s_cmp_ge_u32 s38, 672
    s_cbranch_scc1 L_a_pwo
    s_sub_u32 s37, s38, 448
    s_and_b32 s69, s37, 7
    s_lshr_b32 s37, s37, 3
    s_mov_b32 s16, s42
    s_mov_b32 s17, s43
    s_mov_b32 s18, 0x1c0000
    s_mul_i32 s48, s69, 224
    s_lshl_b32 s49, s37, 2
    s_add_u32 s48, s48, s49
    s_lshl_b32 s48, s48, 10
    s_add_u32 s72, s48, 0x12e0000
    s_mov_b32 s73, 114688
    s_mov_b32 s74, 1024
    s_mov_b32 s75, 2048
    s_branch L_a_pstd2
L_a_pwo:
    s_sub_u32 s37, s38, 672
    s_and_b32 s69, s37, 7
    s_lshr_b32 s37, s37, 3
    s_mov_b32 s16, s40
    s_mov_b32 s17, s41
    s_mov_b32 s18, 0x80000
    s_lshl_b32 s48, s37, 6
    s_lshl_b32 s49, s69, 1
    s_add_u32 s48, s48, s49
    s_lshl_b32 s48, s48, 10
    s_add_u32 s72, s48, 0x590000
    s_cmp_ge_u32 s38, 736
    s_cselect_b32 s72, 0x7fff0000, s72
    s_cselect_b32 s18, 0, s18
    s_mov_b32 s73, 1024
    s_mov_b32 s74, 16384
    s_mov_b32 s75, 32768
L_a_pstd2:
    s_mov_b32 s20, s16
    s_mov_b32 s21, s17
    s_mov_b32 s22, s18
    s_lshl_b32 s48, s37, 16
    s_lshl_b32 s49, s69, 7
    s_add_u32 s48, s48, s49
    s_add_u32 s49, s48, 32768
L_a_pgo:
    s_mov_b32 s51, s72
    s_add_u32 s52, s72, s73
    s_add_u32 s53, s72, s74
    s_add_u32 s54, s52, s74
    s_add_u32 s55, s51, s75
    s_add_u32 s56, s52, s75
    s_add_u32 s57, s53, s75
    s_add_u32 s58, s54, s75
    v_and_b32 v2, 31, v1
    s_lshl_b32 s37, s29, 5
    v_add_u32 v2, s37, v2
    v_lshlrev_b32 v2, 8, v2
    v_lshrrev_b32 v3, 5, v1
    v_and_b32 v4, 15, v1
    v_xor_b32 v4, v3, v4
    v_lshlrev_b32 v4, 4, v4
    s_lshl_b32 s37, s31, 5
    v_xor_b32 v4, s37, v4
    v_xor_b32 v5, 0, v4
    v_add_u32 v16, v2, v5
    v_xor_b32 v5, 32, v4
    v_add_u32 v17, v2, v5
    v_xor_b32 v5, 64, v4
    v_add_u32 v18, v2, v5
    v_xor_b32 v5, 96, v4
    v_add_u32 v19, v2, v5
    v_xor_b32 v5, 128, v4
    v_add_u32 v20, v2, v5
    v_xor_b32 v5, 160, v4
    v_add_u32 v21, v2, v5
    v_xor_b32 v5, 192, v4
    v_add_u32 v22, v2, v5
    v_xor_b32 v5, 224, v4
    v_add_u32 v23, v2, v5
    v_bfe_u32 v4, v1, 2, 2
    v_lshl_add_u32 v4, v3, 3, v4
    v_lshlrev_b32 v4, 7, v4
    v_bfe_u32 v5, v1, 4, 1
    v_lshlrev_b32 v5, 1, v5
    v_bfe_u32 v6, v1, 1, 1
    v_add_u32 v5, v5, v6
    s_lshl_b32 s37, s30, 2
    v_add_u32 v5, s37, v5
    v_bfe_u32 v6, v1, 3, 1
    v_lshlrev_b32 v6, 2, v6
    v_xor_b32 v5, v5, v6
    v_lshlrev_b32 v5, 4, v5
    v_and_b32 v6, 1, v1
    v_lshlrev_b32 v6, 3, v6
    v_add3_u32 v4, v4, v5, v6
    s_lshl_b32 s37, s31, 11
    v_add_u32 v12, s37, v4
    s_xor_b32 s37, s37, 2048
    v_add_u32 v13, s37, v4
    v_add_u32 v14, 0x10000, v12
    v_add_u32 v15, 0x10000, v13
    v_bfe_u32 v5, v1, 4, 1
    v_and_b32 v6, 1, v1
    v_cmp_eq_u32 vcc, v5, v6
    v_mov_b32 v5, s70
    s_nop 0
    v_cndmask_b32 v5, 0, v5, vcc
    v_accvgpr_write_b32 a4, v5
    v_accvgpr_write_b32 a5, v5
    v_accvgpr_write_b32 a6, v5
    v_accvgpr_write_b32 a7, v5
    s_lshl_b32 s72, s29, 1
    s_add_u32 s73, s72, s30
    s_lshl_b32 s73, s73, 8
    s_add_u32 s73, s73, 131072
    s_xor_b32 s74, s73, 256
    s_lshl_b32 s75, s30, 1
    s_add_u32 s75, s75, s29
    s_lshl_b32 s75, s75, 7
    s_add_u32 s75, s75, 132096
    s_xor_b32 s76, s75, 128
    s_lshl_b32 s77, s39, 8
    s_add_u32 s77, s77, 135168
    s_lshl_b32 s40, s28, 2
    s_add_u32 s40, s40, 134144
    s_xor_b32 s41, s40, 4
    v_and_b32 v0, 31, v1
    v_lshlrev_b32 v0, 2, v0
    v_and_b32 v26, 16, v1
    v_cmp_ne_u32 s[82:83], 0, v26
    v_lshlrev_b32 v7, 4, v1
    v_accvgpr_write_b32 a0, s70
    v_accvgpr_write_b32 a1, s70
    v_accvgpr_write_b32 a2, s70
    v_accvgpr_write_b32 a3, s70
    s_lshl_b32 s37, s33, 2
    s_add_u32 s37, s37, s28
    s_lshl_b32 s37, s37, 11
    s_add_u32 s71, s37, 0x580000
    s_lshl_b32 s78, s33, 2
    v_lshlrev_b32 v8, 2, v1
    v_add_u32 v8, 134144, v8
    v_mov_b32 v9, 0
    v_cmp_gt_u32 vcc, 32, v1
    s_nop 0
    s_and_saveexec_b64 s[60:61], vcc
    ds_write_b32 v8, v9
    s_mov_b64 exec, s[60:61]
    s_waitcnt lgkmcnt(0)
    s_barrier
    ds_read_b128 v[112:115], v16 offset:0
    ds_read_b64_tr_b16 v[80:81], v12 offset:16384
    ds_read_b64_tr_b16 v[82:83], v12 offset:16896
    ds_read_b128 v[116:119], v17 offset:0
    ds_read_b64_tr_b16 v[84:85], v13 offset:16384
    ds_read_b64_tr_b16 v[86:87], v13 offset:16896
    ds_read_b128 v[120:123], v18 offset:0
    ds_read_b64_tr_b16 v[88:89], v12 offset:20480
    ds_read_b64_tr_b16 v[90:91], v12 offset:20992
    ds_read_b128 v[124:127], v19 offset:0
    ds_read_b64_tr_b16 v[92:93], v13 offset:20480
    ds_read_b64_tr_b16 v[94:95], v13 offset:20992
    s_waitcnt lgkmcnt(6)
    v_mfma_f32_32x32x16_bf16 v[48:63], v[112:115], v[80:83], 0
    ds_read_b128 v[128:131], v20 offset:0
    ds_read_b64_tr_b16 v[96:97], v12 offset:24576
    ds_read_b64_tr_b16 v[98:99], v12 offset:25088
    v_mfma_f32_16x16x32_bf16 a[8:11], a[4:7], v[80:83], 0
    v_mfma_f32_32x32x16_bf16 v[48:63], v[116:119], v[84:87], v[48:63]
    ds_read_b128 v[132:135], v21 offset:0
    ds_read_b64_tr_b16 v[100:101], v13 offset:24576
    ds_read_b64_tr_b16 v[102:103], v13 offset:25088
    s_waitcnt lgkmcnt(6)
    v_mfma_f32_32x32x16_bf16 v[48:63], v[120:123], v[88:91], v[48:63]
    ds_read_b128 v[136:139], v22 offset:0
    ds_read_b64_tr_b16 v[104:105], v12 offset:28672
    ds_read_b64_tr_b16 v[106:107], v12 offset:29184
    v_mfma_f32_16x16x32_bf16 a[8:11], a[4:7], v[88:91], a[8:11]
    v_mfma_f32_32x32x16_bf16 v[48:63], v[124:127], v[92:95], v[48:63]
    s_barrier
    ds_read_b128 v[140:143], v23 offset:0
    ds_read_b64_tr_b16 v[108:109], v13 offset:28672
    ds_read_b64_tr_b16 v[110:111], v13 offset:29184
    s_waitcnt lgkmcnt(6)
    v_mfma_f32_32x32x16_bf16 v[48:63], v[128:131], v[96:99], v[48:63]
    ds_read_b128 v[144:147], v16 offset:32768
    ds_read_b64_tr_b16 v[80:81], v12 offset:49152
    ds_read_b64_tr_b16 v[82:83], v12 offset:49664
    v_mfma_f32_16x16x32_bf16 a[8:11], a[4:7], v[96:99], a[8:11]
    v_mfma_f32_32x32x16_bf16 v[48:63], v[132:135], v[100:103], v[48:63]
    ds_read_b128 v[148:151], v17 offset:32768
    ds_read_b64_tr_b16 v[84:85], v13 offset:49152
    ds_read_b64_tr_b16 v[86:87], v13 offset:49664
    s_waitcnt lgkmcnt(6)
    v_mfma_f32_32x32x16_bf16 v[48:63], v[136:139], v[104:107], v[48:63]
    ds_read_b128 v[152:155], v18 offset:32768
    ds_read_b64_tr_b16 v[88:89], v12 offset:53248
    ds_read_b64_tr_b16 v[90:91], v12 offset:53760
    v_mfma_f32_16x16x32_bf16 a[8:11], a[4:7], v[104:107], a[8:11]
    v_mfma_f32_32x32x16_bf16 v[48:63], v[140:143], v[108:111], v[48:63]
    ds_read_b128 v[156:159], v19 offset:32768
    ds_read_b64_tr_b16 v[92:93], v13 offset:53248
    ds_read_b64_tr_b16 v[94:95], v13 offset:53760
    s_waitcnt lgkmcnt(6)
    v_mfma_f32_32x32x16_bf16 v[48:63], v[144:147], v[80:83], v[48:63]
    ds_read_b128 v[160:163], v20 offset:32768
    ds_read_b64_tr_b16 v[96:97], v12 offset:57344
    ds_read_b64_tr_b16 v[98:99], v12 offset:57856
    v_mfma_f32_16x16x32_bf16 a[8:11], a[4:7], v[80:83], a[8:11]
    v_mfma_f32_32x32x16_bf16 v[48:63], v[148:151], v[84:87], v[48:63]
    ds_read_b128 v[164:167], v21 offset:32768
    ds_read_b64_tr_b16 v[100:101], v13 offset:57344
    ds_read_b64_tr_b16 v[102:103], v13 offset:57856
    s_waitcnt lgkmcnt(6)
    v_mfma_f32_32x32x16_bf16 v[48:63], v[152:155], v[88:91], v[48:63]
    ds_read_b128 v[168:171], v22 offset:32768
    ds_read_b64_tr_b16 v[104:105], v12 offset:61440
    ds_read_b64_tr_b16 v[106:107], v12 offset:61952
    v_mfma_f32_16x16x32_bf16 a[8:11], a[4:7], v[88:91], a[8:11]
    v_mfma_f32_32x32x16_bf16 v[48:63], v[156:159], v[92:95], v[48:63]
    s_barrier
    ds_read_b128 v[172:175], v23 offset:32768
    ds_read_b64_tr_b16 v[108:109], v13 offset:61440
    ds_read_b64_tr_b16 v[110:111], v13 offset:61952
    s_waitcnt lgkmcnt(6)
    v_mfma_f32_32x32x16_bf16 v[48:63], v[160:163], v[96:99], v[48:63]
    v_add_u32 v16, 0x10000, v16
    v_add_u32 v17, 0x10000, v17
    v_add_u32 v18, 0x10000, v18
    v_add_u32 v19, 0x10000, v19
    v_add_u32 v20, 0x10000, v20
    v_add_u32 v21, 0x10000, v21
    v_add_u32 v22, 0x10000, v22
    v_add_u32 v23, 0x10000, v23
    ds_read_b128 v[176:179], v16 offset:0
    ds_read_b64_tr_b16 v[80:81], v14 offset:16384
    ds_read_b64_tr_b16 v[82:83], v14 offset:16896
    v_mfma_f32_16x16x32_bf16 a[8:11], a[4:7], v[96:99], a[8:11]
    v_mfma_f32_32x32x16_bf16 v[48:63], v[164:167], v[100:103], v[48:63]
    ds_read_b128 v[180:183], v17 offset:0
    ds_read_b64_tr_b16 v[84:85], v15 offset:16384
    ds_read_b64_tr_b16 v[86:87], v15 offset:16896
    s_waitcnt lgkmcnt(6)
    v_mfma_f32_32x32x16_bf16 v[48:63], v[168:171], v[104:107], v[48:63]
    ds_read_b128 v[184:187], v18 offset:0
    ds_read_b64_tr_b16 v[88:89], v14 offset:20480
    ds_read_b64_tr_b16 v[90:91], v14 offset:20992
    v_mfma_f32_16x16x32_bf16 a[8:11], a[4:7], v[104:107], a[8:11]
    v_mfma_f32_32x32x16_bf16 v[48:63], v[172:175], v[108:111], v[48:63]
    ds_read_b128 v[188:191], v19 offset:0
    ds_read_b64_tr_b16 v[92:93], v15 offset:20480
    ds_read_b64_tr_b16 v[94:95], v15 offset:20992
    s_waitcnt lgkmcnt(6)
    v_mfma_f32_32x32x16_bf16 v[48:63], v[176:179], v[80:83], v[48:63]
    ds_read_b128 v[192:195], v20 offset:0
    ds_read_b64_tr_b16 v[96:97], v14 offset:24576
    ds_read_b64_tr_b16 v[98:99], v14 offset:25088
    v_mfma_f32_16x16x32_bf16 a[8:11], a[4:7], v[80:83], a[8:11]
    v_mfma_f32_32x32x16_bf16 v[48:63], v[180:183], v[84:87], v[48:63]
    ds_read_b128 v[196:199], v21 offset:0
    ds_read_b64_tr_b16 v[100:101], v15 offset:24576
    ds_read_b64_tr_b16 v[102:103], v15 offset:25088
    s_waitcnt lgkmcnt(6)
    v_mfma_f32_32x32x16_bf16 v[48:63], v[184:187], v[88:91], v[48:63]
    ds_read_b128 v[200:203], v22 offset:0
    ds_read_b64_tr_b16 v[104:105], v14 offset:28672
    ds_read_b64_tr_b16 v[106:107], v14 offset:29184
    v_mfma_f32_16x16x32_bf16 a[8:11], a[4:7], v[88:91], a[8:11]
    v_mfma_f32_32x32x16_bf16 v[48:63], v[188:191], v[92:95], v[48:63]
    s_barrier
    ds_read_b128 v[204:207], v23 offset:0
    ds_read_b64_tr_b16 v[108:109], v15 offset:28672
    ds_read_b64_tr_b16 v[110:111], v15 offset:29184
    s_waitcnt lgkmcnt(6)
    v_mfma_f32_32x32x16_bf16 v[48:63], v[192:195], v[96:99], v[48:63]
    ds_read_b128 v[208:211], v16 offset:32768
    ds_read_b64_tr_b16 v[80:81], v14 offset:49152
    ds_read_b64_tr_b16 v[82:83], v14 offset:49664
    v_mfma_f32_16x16x32_bf16 a[8:11], a[4:7], v[96:99], a[8:11]
    v_mfma_f32_32x32x16_bf16 v[48:63], v[196:199], v[100:103], v[48:63]
    ds_read_b128 v[212:215], v17 offset:32768
    ds_read_b64_tr_b16 v[84:85], v15 offset:49152
    ds_read_b64_tr_b16 v[86:87], v15 offset:49664
    s_waitcnt lgkmcnt(6)
    v_mfma_f32_32x32x16_bf16 v[48:63], v[200:203], v[104:107], v[48:63]
    ds_read_b128 v[216:219], v18 offset:32768
    ds_read_b64_tr_b16 v[88:89], v14 offset:53248
    ds_read_b64_tr_b16 v[90:91], v14 offset:53760
    v_mfma_f32_16x16x32_bf16 a[8:11], a[4:7], v[104:107], a[8:11]
    v_mfma_f32_32x32x16_bf16 v[48:63], v[204:207], v[108:111], v[48:63]
    ds_read_b128 v[220:223], v19 offset:32768
    ds_read_b64_tr_b16 v[92:93], v15 offset:53248
    ds_read_b64_tr_b16 v[94:95], v15 offset:53760
    s_waitcnt lgkmcnt(6)
    v_mfma_f32_32x32x16_bf16 v[48:63], v[208:211], v[80:83], v[48:63]
    ds_read_b128 v[224:227], v20 offset:32768
    ds_read_b64_tr_b16 v[96:97], v14 offset:57344
    ds_read_b64_tr_b16 v[98:99], v14 offset:57856
    v_mfma_f32_16x16x32_bf16 a[8:11], a[4:7], v[80:83], a[8:11]
    v_mfma_f32_32x32x16_bf16 v[48:63], v[212:215], v[84:87], v[48:63]
    ds_read_b128 v[228:231], v21 offset:32768
    ds_read_b64_tr_b16 v[100:101], v15 offset:57344
    ds_read_b64_tr_b16 v[102:103], v15 offset:57856
    s_waitcnt lgkmcnt(6)
    v_mfma_f32_32x32x16_bf16 v[48:63], v[216:219], v[88:91], v[48:63]
    ds_read_b128 v[232:235], v22 offset:32768
    ds_read_b64_tr_b16 v[104:105], v14 offset:61440
    ds_read_b64_tr_b16 v[106:107], v14 offset:61952
    v_mfma_f32_16x16x32_bf16 a[8:11], a[4:7], v[88:91], a[8:11]
    v_mfma_f32_32x32x16_bf16 v[48:63], v[220:223], v[92:95], v[48:63]
    s_barrier
    s_waitcnt vmcnt(0)
    ds_read_b128 v[236:239], v23 offset:32768
    ds_read_b64_tr_b16 v[108:109], v15 offset:61440
    ds_read_b64_tr_b16 v[110:111], v15 offset:61952
    s_waitcnt lgkmcnt(6)
    v_mfma_f32_32x32x16_bf16 v[48:63], v[224:227], v[96:99], v[48:63]
    ds_read_b64_tr_b16 v[80:81], v12 offset:0
    ds_read_b64_tr_b16 v[82:83], v12 offset:512
    v_mfma_f32_16x16x32_bf16 a[8:11], a[4:7], v[96:99], a[8:11]
    v_mfma_f32_32x32x16_bf16 v[48:63], v[228:231], v[100:103], v[48:63]
    ds_read_b64_tr_b16 v[84:85], v13 offset:0
    ds_read_b64_tr_b16 v[86:87], v13 offset:512
    s_waitcnt lgkmcnt(4)
    v_mfma_f32_32x32x16_bf16 v[48:63], v[232:235], v[104:107], v[48:63]
    ds_read_b64_tr_b16 v[88:89], v12 offset:4096
    ds_read_b64_tr_b16 v[90:91], v12 offset:4608
    v_mfma_f32_16x16x32_bf16 a[8:11], a[4:7], v[104:107], a[8:11]
    v_mfma_f32_32x32x16_bf16 v[48:63], v[236:239], v[108:111], v[48:63]
    ds_read_b64_tr_b16 v[92:93], v13 offset:4096
    ds_read_b64_tr_b16 v[94:95], v13 offset:4608
    s_nop 4
    v_accvgpr_read_b32 v4, a8
    v_accvgpr_read_b32 v27, a9
    v_cndmask_b32 v4, v4, v27, s[82:83]
    v_add_u32 v26, s75, v0
    ds_write_b32 v26, v4
    s_waitcnt lgkmcnt(0)
    v_mfma_f32_32x32x16_bf16 v[64:79], v[112:115], v[80:83], 0
    ds_read_b64_tr_b16 v[96:97], v12 offset:8192
    ds_read_b64_tr_b16 v[98:99], v12 offset:8704
    v_mfma_f32_16x16x32_bf16 a[12:15], a[4:7], v[80:83], 0
    v_mfma_f32_32x32x16_bf16 v[64:79], v[116:119], v[84:87], v[64:79]
    ds_read_b64_tr_b16 v[100:101], v13 offset:8192
    ds_read_b64_tr_b16 v[102:103], v13 offset:8704
    s_barrier
    v_add_u32 v26, s76, v0
    ds_read_b32 v30, v26
    v_lshlrev_b32 v26, 1, v0
    v_add_u32 v27, s74, v26
    v_add_u32 v26, s73, v26
    ds_read_b64 v[24:25], v26
    ds_read_b64 v[28:29], v27
    s_waitcnt lgkmcnt(0)
    v_add_f32 v24, v24, v28
    v_add_f32 v25, v25, v29
    v_mul_f32 v2, 0x3b000000, v24
    v_mul_f32 v25, 0x3b000000, v25
    v_fma_f32 v25, -v2, v2, v25
    v_max_f32 v25, 0, v25
    v_add_f32 v25, 0x3727c5ac, v25
    v_rsq_f32 v3, v25
    v_add_f32 v4, v4, v30
    v_add_u32 v26, s77, v0
    ds_write_b32 v26, v2
    ds_write_b32 v26, v3 offset:128
    v_lshrrev_b32 v26, 5, v1
    v_lshlrev_b32 v26, 4, v26
    v_add_u32 v6, s77, v26
    v_mfma_f32_32x32x16_bf16 v[64:79], v[120:123], v[88:91], v[64:79]
    ds_read_b64_tr_b16 v[104:105], v12 offset:12288
    ds_read_b64_tr_b16 v[106:107], v12 offset:12800
    v_mfma_f32_16x16x32_bf16 a[12:15], a[4:7], v[88:91], a[12:15]
    ds_read_b128 v[16:19], v6 offset:0
    ds_read_b128 v[32:35], v6 offset:128
    ds_read_b128 v[20:23], v6 offset:32
    ds_read_b128 v[36:39], v6 offset:160
    ds_read_b128 v[24:27], v6 offset:64
    ds_read_b128 v[40:43], v6 offset:192
    ds_read_b128 v[28:31], v6 offset:96
    ds_read_b128 v[44:47], v6 offset:224
    v_mfma_f32_32x32x16_bf16 v[64:79], v[124:127], v[92:95], v[64:79]
    ds_read_b64_tr_b16 v[108:109], v13 offset:12288
    ds_read_b64_tr_b16 v[110:111], v13 offset:12800
    v_mfma_f32_32x32x16_bf16 v[64:79], v[128:131], v[96:99], v[64:79]
    ds_read_b64_tr_b16 v[80:81], v12 offset:16384
    ds_read_b64_tr_b16 v[82:83], v12 offset:16896
    v_mfma_f32_16x16x32_bf16 a[12:15], a[4:7], v[96:99], a[12:15]
    s_waitcnt lgkmcnt(11)
    v_fma_f32 v48, -v16, v4, v48
    v_fma_f32 v49, -v17, v4, v49
    s_waitcnt lgkmcnt(10)
    v_fma_f32 v48, v32, v48, s81
    v_fma_f32 v49, v33, v49, s81
    v_mfma_f32_32x32x16_bf16 v[64:79], v[132:135], v[100:103], v[64:79]
    ds_read_b64_tr_b16 v[84:85], v13 offset:16384
    ds_read_b64_tr_b16 v[86:87], v13 offset:16896
    v_mul_f32 v8, 0x3fb8aa3b, v48
    v_mul_f32 v9, 0x3fb8aa3b, v49
    v_exp_f32_e64 v8, v8 clamp
    v_exp_f32_e64 v9, v9 clamp
    s_waitcnt lgkmcnt(4)
    v_mfma_f32_32x32x16_bf16 v[64:79], v[136:139], v[104:107], v[64:79]
    ds_read_b64_tr_b16 v[88:89], v12 offset:20480
    ds_read_b64_tr_b16 v[90:91], v12 offset:20992
    v_mfma_f32_16x16x32_bf16 a[12:15], a[4:7], v[104:107], a[12:15]
    v_max_f32 v48, s81, v48
    v_max_f32 v49, s81, v49
    v_add_f32 v48, v48, v8
    v_add_f32 v49, v49, v9
    v_mfma_f32_32x32x16_bf16 v[64:79], v[140:143], v[108:111], v[64:79]
    ds_read_b64_tr_b16 v[92:93], v13 offset:20480
    ds_read_b64_tr_b16 v[94:95], v13 offset:20992
    v_cvt_pk_bf16_f32 v48, v48, v49
    v_fma_f32 v50, -v18, v4, v50
    v_fma_f32 v51, -v19, v4, v51
    v_fma_f32 v50, v34, v50, s81
    s_waitcnt lgkmcnt(4)
    v_mfma_f32_32x32x16_bf16 v[64:79], v[144:147], v[80:83], v[64:79]
    ds_read_b64_tr_b16 v[96:97], v12 offset:24576
    ds_read_b64_tr_b16 v[98:99], v12 offset:25088
    v_mfma_f32_16x16x32_bf16 a[12:15], a[4:7], v[80:83], a[12:15]
    v_fma_f32 v51, v35, v51, s81
    v_mul_f32 v8, 0x3fb8aa3b, v50
    v_mul_f32 v9, 0x3fb8aa3b, v51
    v_exp_f32_e64 v8, v8 clamp
    v_mfma_f32_32x32x16_bf16 v[64:79], v[148:151], v[84:87], v[64:79]
    ds_read_b64_tr_b16 v[100:101], v13 offset:24576
    ds_read_b64_tr_b16 v[102:103], v13 offset:25088
    v_exp_f32_e64 v9, v9 clamp
    v_max_f32 v50, s81, v50
    v_max_f32 v51, s81, v51
    v_add_f32 v50, v50, v8
    s_waitcnt lgkmcnt(4)
    v_mfma_f32_32x32x16_bf16 v[64:79], v[152:155], v[88:91], v[64:79]
    ds_read_b64_tr_b16 v[104:105], v12 offset:28672
    ds_read_b64_tr_b16 v[106:107], v12 offset:29184
    v_mfma_f32_16x16x32_bf16 a[12:15], a[4:7], v[88:91], a[12:15]
    v_add_f32 v51, v51, v9
    v_cvt_pk_bf16_f32 v49, v50, v51
    v_fma_f32 v52, -v20, v4, v52
    v_fma_f32 v53, -v21, v4, v53
    v_mov_b32 v6, 0
    buffer_load_dword v11, v6, s[24:27], s78 offen sc1
    v_mfma_f32_32x32x16_bf16 v[64:79], v[156:159], v[92:95], v[64:79]
    ds_read_b64_tr_b16 v[108:109], v13 offset:28672
    ds_read_b64_tr_b16 v[110:111], v13 offset:29184
    s_waitcnt lgkmcnt(0)
    s_barrier
    v_fma_f32 v52, v36, v52, s81
    v_fma_f32 v53, v37, v53, s81
    v_mul_f32 v8, 0x3fb8aa3b, v52
    v_mul_f32 v9, 0x3fb8aa3b, v53
    v_mfma_f32_32x32x16_bf16 v[64:79], v[160:163], v[96:99], v[64:79]
    ds_read_b64_tr_b16 v[80:81], v12 offset:32768
    ds_read_b64_tr_b16 v[82:83], v12 offset:33280
    v_mfma_f32_16x16x32_bf16 a[12:15], a[4:7], v[96:99], a[12:15]
    v_exp_f32_e64 v8, v8 clamp
    v_exp_f32_e64 v9, v9 clamp
    v_max_f32 v52, s81, v52
    v_max_f32 v53, s81, v53
    v_mfma_f32_32x32x16_bf16 v[64:79], v[164:167], v[100:103], v[64:79]
    ds_read_b64_tr_b16 v[84:85], v13 offset:32768
    ds_read_b64_tr_b16 v[86:87], v13 offset:33280
    v_add_f32 v52, v52, v8
    v_add_f32 v53, v53, v9
    v_cvt_pk_bf16_f32 v50, v52, v53
    v_fma_f32 v54, -v22, v4, v54
    v_mfma_f32_32x32x16_bf16 v[64:79], v[168:171], v[104:107], v[64:79]
    ds_read_b64_tr_b16 v[88:89], v12 offset:36864
    ds_read_b64_tr_b16 v[90:91], v12 offset:37376
    v_mfma_f32_16x16x32_bf16 a[12:15], a[4:7], v[104:107], a[12:15]
    v_fma_f32 v55, -v23, v4, v55
    v_fma_f32 v54, v38, v54, s81
    v_fma_f32 v55, v39, v55, s81
    v_mul_f32 v8, 0x3fb8aa3b, v54
    v_mfma_f32_32x32x16_bf16 v[64:79], v[172:175], v[108:111], v[64:79]
    ds_read_b64_tr_b16 v[92:93], v13 offset:36864
    ds_read_b64_tr_b16 v[94:95], v13 offset:37376
    v_mul_f32 v9, 0x3fb8aa3b, v55
    v_exp_f32_e64 v8, v8 clamp
    v_exp_f32_e64 v9, v9 clamp
    v_max_f32 v54, s81, v54
    s_waitcnt lgkmcnt(4)
    v_mfma_f32_32x32x16_bf16 v[64:79], v[176:179], v[80:83], v[64:79]
    ds_read_b64_tr_b16 v[96:97], v12 offset:40960
    ds_read_b64_tr_b16 v[98:99], v12 offset:41472
    v_mfma_f32_16x16x32_bf16 a[12:15], a[4:7], v[80:83], a[12:15]
    v_max_f32 v55, s81, v55
    v_add_f32 v54, v54, v8
    v_add_f32 v55, v55, v9
    v_cvt_pk_bf16_f32 v51, v54, v55
    v_mfma_f32_32x32x16_bf16 v[64:79], v[180:183], v[84:87], v[64:79]
    ds_read_b64_tr_b16 v[100:101], v13 offset:40960
    ds_read_b64_tr_b16 v[102:103], v13 offset:41472
    v_fma_f32 v56, -v24, v4, v56
    v_fma_f32 v57, -v25, v4, v57
    v_fma_f32 v56, v40, v56, s81
    v_fma_f32 v57, v41, v57, s81
    s_waitcnt lgkmcnt(4)
    v_mfma_f32_32x32x16_bf16 v[64:79], v[184:187], v[88:91], v[64:79]
    ds_read_b64_tr_b16 v[104:105], v12 offset:45056
    ds_read_b64_tr_b16 v[106:107], v12 offset:45568
    v_mfma_f32_16x16x32_bf16 a[12:15], a[4:7], v[88:91], a[12:15]
    v_mul_f32 v8, 0x3fb8aa3b, v56
    v_mul_f32 v9, 0x3fb8aa3b, v57
    v_exp_f32_e64 v8, v8 clamp
    v_exp_f32_e64 v9, v9 clamp
    v_mfma_f32_32x32x16_bf16 v[64:79], v[188:191], v[92:95], v[64:79]
    ds_read_b64_tr_b16 v[108:109], v13 offset:45056
    ds_read_b64_tr_b16 v[110:111], v13 offset:45568
    v_max_f32 v56, s81, v56
    v_max_f32 v57, s81, v57
    v_add_f32 v56, v56, v8
    v_add_f32 v57, v57, v9
    s_waitcnt lgkmcnt(4)
    v_mfma_f32_32x32x16_bf16 v[64:79], v[192:195], v[96:99], v[64:79]
    ds_read_b64_tr_b16 v[80:81], v12 offset:49152
    ds_read_b64_tr_b16 v[82:83], v12 offset:49664
    v_mfma_f32_16x16x32_bf16 a[12:15], a[4:7], v[96:99], a[12:15]
    v_cvt_pk_bf16_f32 v52, v56, v57
    v_fma_f32 v58, -v26, v4, v58
    v_fma_f32 v59, -v27, v4, v59
    v_fma_f32 v58, v42, v58, s81
    v_lshrrev_b32 v10, 3, v1
    v_mul_lo_u32 v10, v10, s50
    v_and_b32 v6, 7, v1
    v_mfma_f32_32x32x16_bf16 v[64:79], v[196:199], v[100:103], v[64:79]
    ds_read_b64_tr_b16 v[84:85], v13 offset:49152
    ds_read_b64_tr_b16 v[86:87], v13 offset:49664
    v_fma_f32 v59, v43, v59, s81
    v_mul_f32 v8, 0x3fb8aa3b, v58
    v_mul_f32 v9, 0x3fb8aa3b, v59
    v_exp_f32_e64 v8, v8 clamp
    v_lshlrev_b32 v6, 4, v6
    v_add_u32 v10, v10, v6
    s_lshl_b32 s80, s50, 3
    s_waitcnt lgkmcnt(4)
    v_mfma_f32_32x32x16_bf16 v[64:79], v[200:203], v[104:107], v[64:79]
    ds_read_b64_tr_b16 v[88:89], v12 offset:53248
    ds_read_b64_tr_b16 v[90:91], v12 offset:53760
    v_mfma_f32_16x16x32_bf16 a[12:15], a[4:7], v[104:107], a[12:15]
    v_exp_f32_e64 v9, v9 clamp
    v_max_f32 v58, s81, v58
    v_max_f32 v59, s81, v59
    v_add_f32 v58, v58, v8
    s_lshl_b32 s79, s28, 13
    s_add_u32 m0, s79, 0
    v_mfma_f32_32x32x16_bf16 v[64:79], v[204:207], v[108:111], v[64:79]
    ds_read_b64_tr_b16 v[92:93], v13 offset:53248
    ds_read_b64_tr_b16 v[94:95], v13 offset:53760
    v_add_f32 v59, v59, v9
    v_cvt_pk_bf16_f32 v53, v58, v59
    v_fma_f32 v60, -v28, v4, v60
    v_fma_f32 v61, -v29, v4, v61
    buffer_load_dwordx4 v10, s[16:19], s48 offen lds
    s_add_u32 s48, s48, s80
    s_add_u32 m0, s79, 1024
    s_waitcnt lgkmcnt(4)
    v_mfma_f32_32x32x16_bf16 v[64:79], v[208:211], v[80:83], v[64:79]
    ds_read_b64_tr_b16 v[96:97], v12 offset:57344
    ds_read_b64_tr_b16 v[98:99], v12 offset:57856
    v_mfma_f32_16x16x32_bf16 a[12:15], a[4:7], v[80:83], a[12:15]
    v_fma_f32 v60, v44, v60, s81
    v_fma_f32 v61, v45, v61, s81
    v_mul_f32 v8, 0x3fb8aa3b, v60
    v_mul_f32 v9, 0x3fb8aa3b, v61
    buffer_load_dwordx4 v10, s[16:19], s48 offen lds
    s_add_u32 s48, s48, s80
    v_mfma_f32_32x32x16_bf16 v[64:79], v[212:215], v[84:87], v[64:79]
    ds_read_b64_tr_b16 v[100:101], v13 offset:57344
    ds_read_b64_tr_b16 v[102:103], v13 offset:57856
    v_exp_f32_e64 v8, v8 clamp
    v_exp_f32_e64 v9, v9 clamp
    v_max_f32 v60, s81, v60
    v_max_f32 v61, s81, v61
    s_add_u32 m0, s79, 2048
    s_nop 0
    buffer_load_dwordx4 v10, s[16:19], s48 offen lds
    s_add_u32 s48, s48, s80
    s_waitcnt lgkmcnt(4)
    v_mfma_f32_32x32x16_bf16 v[64:79], v[216:219], v[88:91], v[64:79]
    ds_read_b64_tr_b16 v[104:105], v12 offset:61440
    ds_read_b64_tr_b16 v[106:107], v12 offset:61952
    v_mfma_f32_16x16x32_bf16 a[12:15], a[4:7], v[88:91], a[12:15]
    v_add_f32 v60, v60, v8
    v_add_f32 v61, v61, v9
    v_cvt_pk_bf16_f32 v54, v60, v61
    v_fma_f32 v62, -v30, v4, v62
    s_add_u32 m0, s79, 3072
    s_nop 0
    buffer_load_dwordx4 v10, s[16:19], s48 offen lds
    s_add_u32 s48, s48, s80
    v_mfma_f32_32x32x16_bf16 v[64:79], v[220:223], v[92:95], v[64:79]
    ds_read_b64_tr_b16 v[108:109], v13 offset:61440
    ds_read_b64_tr_b16 v[110:111], v13 offset:61952
    v_fma_f32 v63, -v31, v4, v63
    v_fma_f32 v62, v46, v62, s81
    v_fma_f32 v63, v47, v63, s81
    v_mul_f32 v8, 0x3fb8aa3b, v62
    s_add_u32 m0, s79, 4096
    s_nop 0
    buffer_load_dwordx4 v10, s[20:23], s49 offen lds
    s_waitcnt lgkmcnt(4)
    v_mfma_f32_32x32x16_bf16 v[64:79], v[224:227], v[96:99], v[64:79]
    v_mfma_f32_16x16x32_bf16 a[12:15], a[4:7], v[96:99], a[12:15]
    v_mul_f32 v9, 0x3fb8aa3b, v63
    v_exp_f32_e64 v8, v8 clamp
    v_exp_f32_e64 v9, v9 clamp
    v_max_f32 v62, s81, v62
    s_add_u32 s49, s49, s80
    s_add_u32 m0, s79, 5120
    s_nop 0
    buffer_load_dwordx4 v10, s[20:23], s49 offen lds
    v_mfma_f32_32x32x16_bf16 v[64:79], v[228:231], v[100:103], v[64:79]
    v_max_f32 v63, s81, v63
    v_add_f32 v62, v62, v8
    v_add_f32 v63, v63, v9
    v_cvt_pk_bf16_f32 v55, v62, v63
    s_add_u32 s49, s49, s80
    s_add_u32 m0, s79, 6144
    s_waitcnt lgkmcnt(0)
    v_mfma_f32_32x32x16_bf16 v[64:79], v[232:235], v[104:107], v[64:79]
    v_mfma_f32_16x16x32_bf16 a[12:15], a[4:7], v[104:107], a[12:15]
    buffer_load_dwordx4 v10, s[20:23], s49 offen lds
    s_add_u32 s49, s49, s80
    s_add_u32 m0, s79, 7168
    v_mfma_f32_32x32x16_bf16 v[64:79], v[236:239], v[108:111], v[64:79]
    buffer_load_dwordx4 v10, s[20:23], s49 offen lds
    s_add_u32 s49, s49, s80
    s_nop 1
    v_accvgpr_read_b32 v5, a12
    v_accvgpr_read_b32 v56, a13
    v_cndmask_b32 v5, v5, v56, s[82:83]
    v_add_u32 v56, s75, v0
    ds_write_b32 v56, v5 offset:512
    v_mov_b32 v57, s40
    v_mov_b32 v58, 1
    ds_write_b32 v57, v58
    v_bfe_u32 v144, v1, 2, 2
    v_lshrrev_b32 v145, 5, v1
    v_lshl_add_u32 v144, v145, 2, v144
    v_lshlrev_b32 v144, 7, v144
    v_and_b32 v145, 3, v1
    v_lshl_add_u32 v144, v145, 3, v144
    v_bfe_u32 v145, v1, 4, 1
    s_cmp_eq_u32 s68, 1
    s_cselect_b32 s79, 12, 5
    s_cselect_b32 s60, 32, 64
    s_cselect_b32 s61, 64, 2048
    s_cselect_b32 s62, 11, 12
    s_lshl_b32 s62, 1, s62
    v_lshlrev_b32 v145, s79, v145
    s_lshl_b32 s80, s28, 13
    v_add3_u32 v144, v144, v145, s80
    v_add_u32 v145, s60, v144
    v_add_u32 v146, s61, v144
    v_add_u32 v147, s61, v145
    v_add_u32 v148, s62, v144
    v_add_u32 v149, s62, v145
    v_add_u32 v150, s62, v146
    v_add_u32 v151, s62, v147
    v_mov_b32 v57, s41
L_a_pw0:
    ds_read_b32 v58, v57
    s_waitcnt lgkmcnt(0)
    v_readfirstlane_b32 s79, v58
    s_nop 0
    s_cmp_eq_u32 s79, 0
    s_cbranch_scc1 L_a_pw0
    v_add_u32 v56, s76, v0
    ds_read_b32 v57, v56 offset:512
    s_waitcnt lgkmcnt(0)
    v_add_f32 v5, v5, v57
    v_fma_f32 v64, -v16, v5, v64
    v_fma_f32 v65, -v17, v5, v65
    v_fma_f32 v66, -v18, v5, v66
    v_fma_f32 v67, -v19, v5, v67
    v_fma_f32 v68, -v20, v5, v68
    v_fma_f32 v69, -v21, v5, v69
    v_fma_f32 v70, -v22, v5, v70
    v_fma_f32 v71, -v23, v5, v71
    v_fma_f32 v72, -v24, v5, v72
    v_fma_f32 v73, -v25, v5, v73
    v_fma_f32 v74, -v26, v5, v74
    v_fma_f32 v75, -v27, v5, v75
    v_fma_f32 v76, -v28, v5, v76
    v_fma_f32 v77, -v29, v5, v77
    v_fma_f32 v78, -v30, v5, v78
    v_fma_f32 v79, -v31, v5, v79
    v_mul_f32 v64, v32, v64
    v_mul_f32 v65, v33, v65
    v_mul_f32 v66, v34, v66
    v_mul_f32 v67, v35, v67
    v_mul_f32 v68, v36, v68
    v_mul_f32 v69, v37, v69
    v_mul_f32 v70, v38, v70
    v_mul_f32 v71, v39, v71
    v_mul_f32 v72, v40, v72
    v_mul_f32 v73, v41, v73
    v_mul_f32 v74, v42, v74
    v_mul_f32 v75, v43, v75
    v_mul_f32 v76, v44, v76
    v_mul_f32 v77, v45, v77
    v_mul_f32 v78, v46, v78
    v_mul_f32 v79, v47, v79
    v_cvt_pk_bf16_f32 v64, v64, v65
    v_cvt_pk_bf16_f32 v65, v66, v67
    v_cvt_pk_bf16_f32 v66, v68, v69
    v_cvt_pk_bf16_f32 v67, v70, v71
    v_cvt_pk_bf16_f32 v68, v72, v73
    v_cvt_pk_bf16_f32 v69, v74, v75
    v_cvt_pk_bf16_f32 v70, v76, v77
    v_cvt_pk_bf16_f32 v71, v78, v79
    v_mfma_f32_32x32x16_bf16 v[16:31], v[48:51], v[64:67], 0
    v_mfma_f32_32x32x16_bf16 v[32:47], v[48:51], a[0:3], 0
    v_mfma_f32_32x32x16_bf16 v[16:31], v[52:55], v[68:71], v[16:31]
    v_mfma_f32_32x32x16_bf16 v[32:47], v[52:55], a[0:3], v[32:47]
    v_and_b32 v56, 16, v1
    v_lshlrev_b32 v56, 7, v56
    v_lshrrev_b32 v57, 5, v1
    v_mul_u32_u24 v57, 272, v57
    s_lshl_b32 s79, s30, 1
    s_add_u32 s79, s79, s29
    s_lshl_b32 s79, s79, 12
    s_add_u32 s79, s79, 139264
    v_add3_u32 v56, v56, v57, s79
    v_and_b32 v57, 15, v1
    v_lshl_add_u32 v58, v57, 4, v56
    s_add_u32 s40, s40, 16
    s_add_u32 s41, s41, 16
    v_cndmask_b32 v16, v16, v24, s[82:83]
    v_cndmask_b32 v17, v17, v25, s[82:83]
    v_cndmask_b32 v18, v18, v26, s[82:83]
    v_cndmask_b32 v19, v19, v27, s[82:83]
    v_cndmask_b32 v20, v20, v28, s[82:83]
    v_cndmask_b32 v21, v21, v29, s[82:83]
    v_cndmask_b32 v22, v22, v30, s[82:83]
    v_cndmask_b32 v23, v23, v31, s[82:83]
    v_cndmask_b32 v32, v32, v40, s[82:83]
    v_cndmask_b32 v33, v33, v41, s[82:83]
    v_cndmask_b32 v34, v34, v42, s[82:83]
    v_cndmask_b32 v35, v35, v43, s[82:83]
    v_cndmask_b32 v36, v36, v44, s[82:83]
    v_cndmask_b32 v37, v37, v45, s[82:83]
    v_cndmask_b32 v38, v38, v46, s[82:83]
    v_cndmask_b32 v39, v39, v47, s[82:83]
    ds_write_b128 v58, v[16:19]
    ds_write_b128 v58, v[20:23] offset:544
    v_cmp_eq_u32 vcc, 0, v57
    s_nop 0
    s_and_saveexec_b64 s[60:61], vcc
    ds_write_b128 v56, v[32:35] offset:256
    ds_write_b128 v56, v[36:39] offset:800
    s_mov_b64 exec, s[60:61]
    v_mov_b32 v57, s40
    v_mov_b32 v58, 1
    ds_write_b32 v57, v58
    s_lshl_b32 s79, s30, 13
    s_lshl_b32 s80, s29, 11
    s_add_u32 s79, s79, s80
    s_add_u32 s79, s79, 139264
    s_waitcnt vmcnt(8)
    v_readfirstlane_b32 s80, v11
    s_nop 0
    s_cmp_eq_u32 s80, 0
    s_cbranch_scc1 L_a_spin
L_a_go:
    v_mov_b32 v57, s41
L_a_pw1:
    ds_read_b32 v58, v57
    s_waitcnt lgkmcnt(0)
    v_readfirstlane_b32 s80, v58
    s_nop 0
    s_cmp_eq_u32 s80, 0
    s_cbranch_scc1 L_a_pw1
    v_lshlrev_b32 v56, 2, v1
    v_add_u32 v57, s79, v56
    ds_read_b32 v16, v57 offset:0
    ds_read_b32 v17, v57 offset:4096
    ds_read_b32 v18, v57 offset:256
    ds_read_b32 v19, v57 offset:4352
    ds_read_b32 v20, v57 offset:512
    ds_read_b32 v21, v57 offset:4608
    ds_read_b32 v22, v57 offset:768
    ds_read_b32 v23, v57 offset:4864
    ds_read_b32 v24, v57 offset:1024
    ds_read_b32 v25, v57 offset:5120
    s_waitcnt vmcnt(0)
    ds_read_b64_tr_b16 v[112:113], v144
    ds_read_b64_tr_b16 v[114:115], v144 offset:1024
    ds_read_b64_tr_b16 v[116:117], v145
    ds_read_b64_tr_b16 v[118:119], v145 offset:1024
    ds_read_b64_tr_b16 v[120:121], v146
    ds_read_b64_tr_b16 v[122:123], v146 offset:1024
    ds_read_b64_tr_b16 v[124:125], v147
    ds_read_b64_tr_b16 v[126:127], v147 offset:1024
    ds_read_b64_tr_b16 v[128:129], v148
    ds_read_b64_tr_b16 v[130:131], v148 offset:1024
    ds_read_b64_tr_b16 v[132:133], v149
    ds_read_b64_tr_b16 v[134:135], v149 offset:1024
    ds_read_b64_tr_b16 v[136:137], v150
    ds_read_b64_tr_b16 v[138:139], v150 offset:1024
    ds_read_b64_tr_b16 v[140:141], v151
    ds_read_b64_tr_b16 v[142:143], v151 offset:1024
    s_waitcnt lgkmcnt(15)
    v_add_f32 v16, v16, v17
    v_add_f32 v18, v18, v19
    v_add_f32 v20, v20, v21
    v_add_f32 v22, v22, v23
    v_add_f32 v24, v24, v25
    buffer_atomic_add_f32 v16, v56, s[12:15], s71 offen offset:0
    buffer_atomic_add_f32 v18, v56, s[12:15], s71 offen offset:256
    buffer_atomic_add_f32 v20, v56, s[12:15], s71 offen offset:512
    buffer_atomic_add_f32 v22, v56, s[12:15], s71 offen offset:768
    v_cmp_gt_u32 vcc, 16, v1
    s_nop 0
    s_and_saveexec_b64 s[60:61], vcc
    buffer_atomic_add_f32 v24, v56, s[12:15], s71 offen offset:1024
    s_mov_b64 exec, s[60:61]
    s_waitcnt lgkmcnt(14)
    buffer_store_dwordx4 v[112:115], v7, s[12:15], s51 offen sc1
    v_mfma_f32_16x16x32_bf16 v[32:35], a[4:7], v[112:115], 0
    s_waitcnt lgkmcnt(12)
    buffer_store_dwordx4 v[116:119], v7, s[12:15], s52 offen sc1
    v_mfma_f32_16x16x32_bf16 v[36:39], a[4:7], v[116:119], 0
    s_waitcnt lgkmcnt(10)
    buffer_store_dwordx4 v[120:123], v7, s[12:15], s53 offen sc1
    v_mfma_f32_16x16x32_bf16 v[40:43], a[4:7], v[120:123], 0
    s_waitcnt lgkmcnt(8)
    buffer_store_dwordx4 v[124:127], v7, s[12:15], s54 offen sc1
    v_mfma_f32_16x16x32_bf16 v[44:47], a[4:7], v[124:127], 0
    s_waitcnt lgkmcnt(6)
    buffer_store_dwordx4 v[128:131], v7, s[12:15], s55 offen sc1
    v_mfma_f32_16x16x32_bf16 v[32:35], a[4:7], v[128:131], v[32:35]
    s_waitcnt lgkmcnt(4)
    buffer_store_dwordx4 v[132:135], v7, s[12:15], s56 offen sc1
    v_mfma_f32_16x16x32_bf16 v[36:39], a[4:7], v[132:135], v[36:39]
    s_waitcnt lgkmcnt(2)
    buffer_store_dwordx4 v[136:139], v7, s[12:15], s57 offen sc1
    v_mfma_f32_16x16x32_bf16 v[40:43], a[4:7], v[136:139], v[40:43]
    s_waitcnt lgkmcnt(0)
    buffer_store_dwordx4 v[140:143], v7, s[12:15], s58 offen sc1
    v_mfma_f32_16x16x32_bf16 v[44:47], a[4:7], v[140:143], v[44:47]
    v_cndmask_b32 v48, v32, v33, s[82:83]
    buffer_store_dword v48, v0, s[12:15], s59 offen offset:0
    v_cndmask_b32 v49, v36, v37, s[82:83]
    buffer_store_dword v49, v0, s[12:15], s59 offen offset:128
    s_nop 0
    v_cndmask_b32 v50, v40, v41, s[82:83]
    buffer_store_dword v50, v0, s[12:15], s59 offen offset:256
    s_nop 0
    v_cndmask_b32 v51, v44, v45, s[82:83]
    buffer_store_dword v51, v0, s[12:15], s59 offen offset:384
L_a_end:
    s_endpgm
L_a_spin:
    s_mov_b32 s84, 0
L_a_spin2:
    s_sleep 2
    v_mov_b32 v6, 0
    buffer_load_dword v11, v6, s[24:27], s78 offen sc1
    s_waitcnt vmcnt(0)
    v_readfirstlane_b32 s80, v11
    s_add_u32 s84, s84, 1
    s_cmp_ge_u32 s84, 0x100000
    s_cbranch_scc1 L_a_go
    s_cmp_eq_u32 s80, 0
    s_cbranch_scc1 L_a_spin2
    s_branch L_a_go

L_a_q:
    s_lshl_b32 s34, s28, 12
    s_lshl_b32 s35, s32, 16
    s_mul_i32 s36, s28, 98304
    s_lshl_b32 s37, s33, 7
    s_add_u32 s36, s36, s37
    s_add_u32 s38, s32, s33
    s_add_u32 s37, s38, 0
    s_and_b32 s37, s37, 3
    s_lshl_b32 s60, s37, 8
    s_add_u32 s60, s60, s35
    s_mul_i32 s64, s37, 393216
    s_add_u32 s64, s64, s36
    s_add_u32 s37, s38, 1
    s_and_b32 s37, s37, 3
    s_lshl_b32 s61, s37, 8
    s_add_u32 s61, s61, s35
    s_mul_i32 s65, s37, 393216
    s_add_u32 s65, s65, s36
    s_add_u32 s37, s38, 2
    s_and_b32 s37, s37, 3
    s_lshl_b32 s62, s37, 8
    s_add_u32 s62, s62, s35
    s_mul_i32 s66, s37, 393216
    s_add_u32 s66, s66, s36
    s_add_u32 s37, s38, 3
    s_and_b32 s37, s37, 3
    s_lshl_b32 s63, s37, 8
    s_add_u32 s63, s63, s35
    s_mul_i32 s67, s37, 393216
    s_add_u32 s67, s67, s36
    v_lshrrev_b32 v2, 4, v1
    v_and_b32 v3, 15, v1
    s_lshl_b32 s37, s28, 4
    v_add_u32 v4, 0, v2
    v_xor_b32 v5, v3, v4
    v_lshlrev_b32 v5, 4, v5
    v_add_u32 v4, s37, v4
    v_lshlrev_b32 v4, 10, v4
    v_add_u32 v4, v4, v5
    v_subrev_u32 v32, 0, v4
    v_add_u32 v4, 4, v2
    v_xor_b32 v5, v3, v4
    v_lshlrev_b32 v5, 4, v5
    v_add_u32 v4, s37, v4
    v_lshlrev_b32 v4, 10, v4
    v_add_u32 v4, v4, v5
    v_subrev_u32 v33, 1024, v4
    v_add_u32 v4, 8, v2
    v_xor_b32 v5, v3, v4
    v_lshlrev_b32 v5, 4, v5
    v_add_u32 v4, s37, v4
    v_lshlrev_b32 v4, 10, v4
    v_add_u32 v4, v4, v5
    v_subrev_u32 v34, 2048, v4
    v_add_u32 v4, 12, v2
    v_xor_b32 v5, v3, v4
    v_lshlrev_b32 v5, 4, v5
    v_add_u32 v4, s37, v4
    v_lshlrev_b32 v4, 10, v4
    v_add_u32 v4, v4, v5
    v_subrev_u32 v35, 3072, v4
    v_lshrrev_b32 v4, 3, v1
    s_movk_i32 s37, 3072
    v_mul_lo_u32 v4, v4, s37
    v_and_b32 v5, 1, v2
    v_lshlrev_b32 v5, 2, v5
    v_and_b32 v6, 7, v1
    v_xor_b32 v5, v5, v6
    v_lshlrev_b32 v5, 4, v5
    v_add_u32 v8, v4, v5
    v_add_u32 v9, 23552, v8
    v_add_u32 v10, 47104, v8
    v_add_u32 v11, 70656, v8
    v_lshlrev_b32 v7, 4, v1
    v_mov_b32 v40, 0
    v_mov_b32 v41, 0
    v_mov_b32 v42, 0
    v_mov_b32 v43, 0
    s_lshl_b32 s37, s33, 2
    s_add_u32 s37, s37, s28
    s_lshl_b32 s37, s37, 11
    s_add_u32 s71, s37, 0x580000
    s_cmp_eq_u32 s32, 0
    s_cselect_b32 s37, s71, 0x7fff0000
    s_waitcnt lgkmcnt(0)
    buffer_store_dwordx4 v[40:43], v7, s[12:15], s37 offen sc1
    buffer_store_dwordx4 v[40:43], v7, s[12:15], s37 offen offset:1024 sc1
    s_lshl_b32 s37, s2, 7
    s_lshl_b32 s38, s28, 15
    s_add_u32 s37, s37, s38
    s_add_u32 s37, s37, 0x14e0000
    v_and_b32 v41, 15, v1
    v_lshlrev_b32 v41, 2, v41
    buffer_store_dword v40, v41, s[12:15], s37 offen
    s_add_u32 m0, s34, 0
    s_nop 0
    buffer_load_dwordx4 v32, s[4:7], s60 offen offset:0 lds
    buffer_load_dwordx4 v33, s[4:7], s60 offen offset:1024 lds
    buffer_load_dwordx4 v34, s[4:7], s60 offen offset:2048 lds
    buffer_load_dwordx4 v35, s[4:7], s60 offen offset:3072 lds
    s_add_u32 m0, s34, 16384
    s_add_u32 s69, s64, 1024
    buffer_load_dwordx4 v8, s[8:11], s69 offen offset:0 lds
    buffer_load_dwordx4 v9, s[8:11], s69 offen offset:1024 lds
    buffer_load_dwordx4 v10, s[8:11], s69 offen offset:2048 lds
    buffer_load_dwordx4 v11, s[8:11], s69 offen offset:3072 lds
    s_add_u32 m0, s34, 32768
    s_nop 0
    buffer_load_dwordx4 v32, s[4:7], s61 offen offset:0 lds
    v_and_b32 v2, 31, v1
    s_lshl_b32 s37, s29, 5
    v_add_u32 v2, s37, v2
    v_lshlrev_b32 v2, 8, v2
    v_lshrrev_b32 v3, 5, v1
    v_and_b32 v4, 15, v1
    v_xor_b32 v4, v3, v4
    v_lshlrev_b32 v4, 4, v4
    s_lshl_b32 s37, s31, 5
    buffer_load_dwordx4 v33, s[4:7], s61 offen offset:1024 lds
    v_xor_b32 v4, s37, v4
    v_xor_b32 v5, 0, v4
    v_add_u32 v16, v2, v5
    v_xor_b32 v5, 32, v4
    v_add_u32 v17, v2, v5
    v_xor_b32 v5, 64, v4
    v_add_u32 v18, v2, v5
    v_xor_b32 v5, 96, v4
    v_add_u32 v19, v2, v5
    v_xor_b32 v5, 128, v4
    buffer_load_dwordx4 v34, s[4:7], s61 offen offset:2048 lds
    v_add_u32 v20, v2, v5
    v_xor_b32 v5, 160, v4
    v_add_u32 v21, v2, v5
    v_xor_b32 v5, 192, v4
    v_add_u32 v22, v2, v5
    v_xor_b32 v5, 224, v4
    v_add_u32 v23, v2, v5
    v_bfe_u32 v4, v1, 2, 2
    v_lshl_add_u32 v4, v3, 3, v4
    buffer_load_dwordx4 v35, s[4:7], s61 offen offset:3072 lds
    v_lshlrev_b32 v4, 7, v4
    v_bfe_u32 v5, v1, 4, 1
    v_lshlrev_b32 v5, 1, v5
    v_bfe_u32 v6, v1, 1, 1
    v_add_u32 v5, v5, v6
    s_lshl_b32 s37, s30, 2
    v_add_u32 v5, s37, v5
    v_bfe_u32 v6, v1, 3, 1
    v_lshlrev_b32 v6, 2, v6
    v_xor_b32 v5, v5, v6
    s_add_u32 m0, s34, 49152
    s_add_u32 s69, s65, 1024
    buffer_load_dwordx4 v8, s[8:11], s69 offen offset:0 lds
    v_lshlrev_b32 v5, 4, v5
    v_and_b32 v6, 1, v1
    v_lshlrev_b32 v6, 3, v6
    v_add3_u32 v4, v4, v5, v6
    s_lshl_b32 s37, s31, 11
    v_add_u32 v12, s37, v4
    s_xor_b32 s37, s37, 2048
    v_add_u32 v13, s37, v4
    v_add_u32 v14, 0x10000, v12
    v_add_u32 v15, 0x10000, v13
    buffer_load_dwordx4 v9, s[8:11], s69 offen offset:1024 lds
    v_bfe_u32 v5, v1, 4, 1
    v_and_b32 v6, 1, v1
    v_cmp_eq_u32 vcc, v5, v6
    v_mov_b32 v5, s70
    s_nop 0
    v_cndmask_b32 v5, 0, v5, vcc
    v_accvgpr_write_b32 a4, v5
    v_accvgpr_write_b32 a5, v5
    v_accvgpr_write_b32 a6, v5
    v_accvgpr_write_b32 a7, v5
    buffer_load_dwordx4 v10, s[8:11], s69 offen offset:2048 lds
    s_lshl_b32 s72, s29, 1
    s_add_u32 s73, s72, s30
    s_lshl_b32 s73, s73, 8
    s_add_u32 s73, s73, 131072
    s_xor_b32 s74, s73, 256
    s_lshl_b32 s75, s30, 1
    s_add_u32 s75, s75, s29
    s_lshl_b32 s75, s75, 7
    s_add_u32 s75, s75, 132096
    s_xor_b32 s76, s75, 128
    buffer_load_dwordx4 v11, s[8:11], s69 offen offset:3072 lds
    s_lshl_b32 s77, s39, 8
    s_add_u32 s77, s77, 135168
    s_lshl_b32 s40, s28, 2
    s_add_u32 s40, s40, 134144
    s_xor_b32 s41, s40, 4
    v_and_b32 v0, 31, v1
    v_lshlrev_b32 v0, 2, v0
    v_and_b32 v26, 16, v1
    v_cmp_ne_u32 s[82:83], 0, v26
    v_lshlrev_b32 v7, 4, v1
    v_mov_b32 v24, 0
    v_mov_b32 v25, 0
    v_mov_b32 v28, 0
    v_mov_b32 v29, 0
    s_waitcnt vmcnt(8)
    s_barrier
    s_add_u32 m0, s34, 65536
    s_nop 0
    buffer_load_dwordx4 v32, s[4:7], s62 offen offset:0 lds
    s_or_b32 s38, s32, s28
    s_cmp_eq_u32 s38, 0
    s_cselect_b32 s38, 0, 0x1000
    v_lshlrev_b32 v26, 12, v1
    buffer_load_dwordx4 v33, s[4:7], s62 offen offset:1024 lds
    s_lshl_b32 s78, s33, 2
    v_add_u32 v26, s78, v26
    v_mov_b32 v27, 1
    ds_read_b128 v[112:115], v16 offset:0
    buffer_load_dwordx4 v34, s[4:7], s62 offen offset:2048 lds
    ds_read_b128 v[116:119], v17 offset:0
    ds_read_b128 v[120:123], v18 offset:0
    ds_read_b128 v[124:127], v19 offset:0
    ds_read_b128 v[128:131], v20 offset:0
    ds_read_b128 v[132:135], v21 offset:0
    buffer_load_dwordx4 v35, s[4:7], s62 offen offset:3072 lds
    ds_read_b128 v[136:139], v22 offset:0
    ds_read_b128 v[140:143], v23 offset:0
    s_waitcnt lgkmcnt(7)
    v_mfma_f32_16x16x32_bf16 a[8:11], a[4:7], v[112:115], 0
    v_dot2c_f32_bf16 v24, v112, v112
    s_add_u32 m0, s34, 81920
    s_add_u32 s69, s66, 1024
    buffer_load_dwordx4 v8, s[8:11], s69 offen offset:0 lds
    v_dot2c_f32_bf16 v25, v113, v113
    v_dot2c_f32_bf16 v28, v114, v114
    v_dot2c_f32_bf16 v29, v115, v115
    s_waitcnt lgkmcnt(5)
    v_mfma_f32_16x16x32_bf16 a[8:11], a[4:7], v[120:123], a[8:11]
    buffer_load_dwordx4 v9, s[8:11], s69 offen offset:1024 lds
    v_dot2c_f32_bf16 v24, v120, v120
    v_dot2c_f32_bf16 v25, v121, v121
    v_dot2c_f32_bf16 v28, v122, v122
    v_dot2c_f32_bf16 v29, v123, v123
    s_waitcnt lgkmcnt(3)
    v_mfma_f32_16x16x32_bf16 a[8:11], a[4:7], v[128:131], a[8:11]
    buffer_load_dwordx4 v10, s[8:11], s69 offen offset:2048 lds
    v_dot2c_f32_bf16 v24, v128, v128
    v_dot2c_f32_bf16 v25, v129, v129
    v_dot2c_f32_bf16 v28, v130, v130
    v_dot2c_f32_bf16 v29, v131, v131
    buffer_load_dwordx4 v11, s[8:11], s69 offen offset:3072 lds
    s_waitcnt lgkmcnt(1)
    v_mfma_f32_16x16x32_bf16 a[8:11], a[4:7], v[136:139], a[8:11]
    v_dot2c_f32_bf16 v24, v136, v136
    v_dot2c_f32_bf16 v25, v137, v137
    v_dot2c_f32_bf16 v28, v138, v138
    v_dot2c_f32_bf16 v29, v139, v139
    buffer_store_dword v27, v26, s[24:27], s38 offen sc1
    s_waitcnt vmcnt(9)
    s_barrier
    s_add_u32 m0, s34, 98304
    s_nop 0
    buffer_load_dwordx4 v32, s[4:7], s63 offen offset:0 lds
    ds_read_b128 v[144:147], v16 offset:32768
    ds_read_b128 v[148:151], v17 offset:32768
    ds_read_b128 v[152:155], v18 offset:32768
    buffer_load_dwordx4 v33, s[4:7], s63 offen offset:1024 lds
    ds_read_b128 v[156:159], v19 offset:32768
    ds_read_b128 v[160:163], v20 offset:32768
    ds_read_b128 v[164:167], v21 offset:32768
    ds_read_b128 v[168:171], v22 offset:32768
    buffer_load_dwordx4 v34, s[4:7], s63 offen offset:2048 lds
    ds_read_b128 v[172:175], v23 offset:32768
    s_waitcnt lgkmcnt(7)
    v_mfma_f32_16x16x32_bf16 a[8:11], a[4:7], v[144:147], a[8:11]
    v_dot2c_f32_bf16 v24, v144, v144
    buffer_load_dwordx4 v35, s[4:7], s63 offen offset:3072 lds
    v_dot2c_f32_bf16 v25, v145, v145
    v_dot2c_f32_bf16 v28, v146, v146
    v_dot2c_f32_bf16 v29, v147, v147
    s_waitcnt lgkmcnt(5)
    v_mfma_f32_16x16x32_bf16 a[8:11], a[4:7], v[152:155], a[8:11]
    s_add_u32 m0, s34, 114688
    s_add_u32 s69, s67, 1024
    buffer_load_dwordx4 v8, s[8:11], s69 offen offset:0 lds
    v_dot2c_f32_bf16 v24, v152, v152
    v_dot2c_f32_bf16 v25, v153, v153
    v_dot2c_f32_bf16 v28, v154, v154
    buffer_load_dwordx4 v9, s[8:11], s69 offen offset:1024 lds
    v_dot2c_f32_bf16 v29, v155, v155
    s_waitcnt lgkmcnt(3)
    v_mfma_f32_16x16x32_bf16 a[8:11], a[4:7], v[160:163], a[8:11]
    v_dot2c_f32_bf16 v24, v160, v160
    v_dot2c_f32_bf16 v25, v161, v161
    buffer_load_dwordx4 v10, s[8:11], s69 offen offset:2048 lds
    v_dot2c_f32_bf16 v28, v162, v162
    v_dot2c_f32_bf16 v29, v163, v163
    s_waitcnt lgkmcnt(1)
    v_mfma_f32_16x16x32_bf16 a[8:11], a[4:7], v[168:171], a[8:11]
    buffer_load_dwordx4 v11, s[8:11], s69 offen offset:3072 lds
    v_dot2c_f32_bf16 v24, v168, v168
    v_dot2c_f32_bf16 v25, v169, v169
    v_dot2c_f32_bf16 v28, v170, v170
    v_dot2c_f32_bf16 v29, v171, v171
    s_waitcnt vmcnt(9)
    s_barrier
    s_add_u32 m0, s34, 0
    s_add_u32 s69, s64, 2048
    buffer_load_dwordx4 v8, s[8:11], s69 offen offset:0 lds
    v_add_u32 v16, 0x10000, v16
    v_add_u32 v17, 0x10000, v17
    v_add_u32 v18, 0x10000, v18
    v_add_u32 v19, 0x10000, v19
    buffer_load_dwordx4 v9, s[8:11], s69 offen offset:1024 lds
    v_add_u32 v20, 0x10000, v20
    v_add_u32 v21, 0x10000, v21
    v_add_u32 v22, 0x10000, v22
    v_add_u32 v23, 0x10000, v23
    ds_read_b128 v[176:179], v16 offset:0
    buffer_load_dwordx4 v10, s[8:11], s69 offen offset:2048 lds
    ds_read_b128 v[180:183], v17 offset:0
    ds_read_b128 v[184:187], v18 offset:0
    ds_read_b128 v[188:191], v19 offset:0
    ds_read_b128 v[192:195], v20 offset:0
    buffer_load_dwordx4 v11, s[8:11], s69 offen offset:3072 lds
    ds_read_b128 v[196:199], v21 offset:0
    ds_read_b128 v[200:203], v22 offset:0
    ds_read_b128 v[204:207], v23 offset:0
    s_waitcnt lgkmcnt(7)
    v_mfma_f32_16x16x32_bf16 a[8:11], a[4:7], v[176:179], a[8:11]
    v_dot2c_f32_bf16 v24, v176, v176
    s_add_u32 m0, s34, 16384
    s_add_u32 s69, s65, 2048
    buffer_load_dwordx4 v8, s[8:11], s69 offen offset:0 lds
    v_dot2c_f32_bf16 v25, v177, v177
    v_dot2c_f32_bf16 v28, v178, v178
    v_dot2c_f32_bf16 v29, v179, v179
    s_waitcnt lgkmcnt(5)
    v_mfma_f32_16x16x32_bf16 a[8:11], a[4:7], v[184:187], a[8:11]
    buffer_load_dwordx4 v9, s[8:11], s69 offen offset:1024 lds
    v_dot2c_f32_bf16 v24, v184, v184
    v_dot2c_f32_bf16 v25, v185, v185
    v_dot2c_f32_bf16 v28, v186, v186
    v_dot2c_f32_bf16 v29, v187, v187
    s_waitcnt lgkmcnt(3)
    v_mfma_f32_16x16x32_bf16 a[8:11], a[4:7], v[192:195], a[8:11]
    buffer_load_dwordx4 v10, s[8:11], s69 offen offset:2048 lds
    v_dot2c_f32_bf16 v24, v192, v192
    v_dot2c_f32_bf16 v25, v193, v193
    v_dot2c_f32_bf16 v28, v194, v194
    v_dot2c_f32_bf16 v29, v195, v195
    buffer_load_dwordx4 v11, s[8:11], s69 offen offset:3072 lds
    s_waitcnt lgkmcnt(1)
    v_mfma_f32_16x16x32_bf16 a[8:11], a[4:7], v[200:203], a[8:11]
    v_dot2c_f32_bf16 v24, v200, v200
    v_dot2c_f32_bf16 v25, v201, v201
    v_dot2c_f32_bf16 v28, v202, v202
    v_dot2c_f32_bf16 v29, v203, v203
    s_waitcnt vmcnt(8)
    s_barrier
    s_add_u32 m0, s34, 32768
    s_add_u32 s69, s66, 2048
    buffer_load_dwordx4 v8, s[8:11], s69 offen offset:0 lds
    ds_read_b128 v[208:211], v16 offset:32768
    ds_read_b128 v[212:215], v17 offset:32768
    ds_read_b128 v[216:219], v18 offset:32768
    buffer_load_dwordx4 v9, s[8:11], s69 offen offset:1024 lds
    ds_read_b128 v[220:223], v19 offset:32768
    ds_read_b128 v[224:227], v20 offset:32768
    ds_read_b128 v[228:231], v21 offset:32768
    ds_read_b128 v[232:235], v22 offset:32768
    buffer_load_dwordx4 v10, s[8:11], s69 offen offset:2048 lds
    ds_read_b128 v[236:239], v23 offset:32768
    s_waitcnt lgkmcnt(7)
    v_mfma_f32_16x16x32_bf16 a[8:11], a[4:7], v[208:211], a[8:11]
    v_dot2c_f32_bf16 v24, v208, v208
    buffer_load_dwordx4 v11, s[8:11], s69 offen offset:3072 lds
    v_dot2c_f32_bf16 v25, v209, v209
    v_dot2c_f32_bf16 v28, v210, v210
    v_dot2c_f32_bf16 v29, v211, v211
    s_waitcnt lgkmcnt(5)
    v_mfma_f32_16x16x32_bf16 a[8:11], a[4:7], v[216:219], a[8:11]
    s_add_u32 m0, s34, 49152
    s_add_u32 s69, s67, 2048
    buffer_load_dwordx4 v8, s[8:11], s69 offen offset:0 lds
    v_dot2c_f32_bf16 v24, v216, v216
    v_dot2c_f32_bf16 v25, v217, v217
    v_dot2c_f32_bf16 v28, v218, v218
    buffer_load_dwordx4 v9, s[8:11], s69 offen offset:1024 lds
    v_dot2c_f32_bf16 v29, v219, v219
    s_waitcnt lgkmcnt(3)
    v_mfma_f32_16x16x32_bf16 a[8:11], a[4:7], v[224:227], a[8:11]
    v_dot2c_f32_bf16 v24, v224, v224
    v_dot2c_f32_bf16 v25, v225, v225
    buffer_load_dwordx4 v10, s[8:11], s69 offen offset:2048 lds
    v_dot2c_f32_bf16 v28, v226, v226
    v_dot2c_f32_bf16 v29, v227, v227
    s_waitcnt lgkmcnt(1)
    v_mfma_f32_16x16x32_bf16 a[8:11], a[4:7], v[232:235], a[8:11]
    buffer_load_dwordx4 v11, s[8:11], s69 offen offset:3072 lds
    v_dot2c_f32_bf16 v24, v232, v232
    v_dot2c_f32_bf16 v25, v233, v233
    v_dot2c_f32_bf16 v28, v234, v234
    v_dot2c_f32_bf16 v29, v235, v235
    s_waitcnt vmcnt(8)
    s_waitcnt lgkmcnt(0)
    s_barrier
    s_add_u32 m0, s34, 65536
    s_add_u32 s69, s64, 0
    buffer_load_dwordx4 v8, s[8:11], s69 offen offset:0 lds
    buffer_load_dwordx4 v9, s[8:11], s69 offen offset:1024 lds
    buffer_load_dwordx4 v10, s[8:11], s69 offen offset:2048 lds
    buffer_load_dwordx4 v11, s[8:11], s69 offen offset:3072 lds
    s_add_u32 m0, s34, 81920
    s_add_u32 s69, s65, 0
    buffer_load_dwordx4 v8, s[8:11], s69 offen offset:0 lds
    buffer_load_dwordx4 v9, s[8:11], s69 offen offset:1024 lds
    buffer_load_dwordx4 v10, s[8:11], s69 offen offset:2048 lds
    buffer_load_dwordx4 v11, s[8:11], s69 offen offset:3072 lds
    v_add_f32 v24, v24, v28
    v_add_f32 v25, v25, v29
    v_add_f32 v25, v24, v25
    v_mov_b32 v26, v25
    s_nop 1
    v_permlane32_swap_b32 v25, v26
    v_add_f32 v25, v25, v26
    v_accvgpr_read_b32 v24, a8
    v_accvgpr_read_b32 v27, a9
    v_cndmask_b32 v24, v24, v27, s[82:83]
    v_lshlrev_b32 v26, 1, v0
    v_add_u32 v26, s73, v26
    ds_write_b64 v26, v[24:25]
    s_waitcnt lgkmcnt(0)
    s_barrier
    v_lshlrev_b32 v26, 1, v0
    v_add_u32 v27, s74, v26
    v_add_u32 v26, s73, v26
    ds_read_b64 v[24:25], v26
    ds_read_b64 v[28:29], v27
    s_waitcnt lgkmcnt(0)
    v_add_f32 v24, v24, v28
    v_add_f32 v25, v25, v29
    v_mul_f32 v2, 0x3b000000, v24
    v_mul_f32 v25, 0x3b000000, v25
    v_fma_f32 v25, -v2, v2, v25
    v_max_f32 v25, 0, v25
    v_add_f32 v25, 0x3727c5ac, v25
    v_rsq_f32 v3, v25
    s_add_u32 m0, s34, 98304
    s_add_u32 s69, s66, 0
    buffer_load_dwordx4 v8, s[8:11], s69 offen offset:0 lds
    buffer_load_dwordx4 v9, s[8:11], s69 offen offset:1024 lds
    buffer_load_dwordx4 v10, s[8:11], s69 offen offset:2048 lds
    buffer_load_dwordx4 v11, s[8:11], s69 offen offset:3072 lds
    s_add_u32 m0, s34, 114688
    s_add_u32 s69, s67, 0
    buffer_load_dwordx4 v8, s[8:11], s69 offen offset:0 lds
    buffer_load_dwordx4 v9, s[8:11], s69 offen offset:1024 lds
    buffer_load_dwordx4 v10, s[8:11], s69 offen offset:2048 lds
    buffer_load_dwordx4 v11, s[8:11], s69 offen offset:3072 lds
    s_waitcnt vmcnt(16)
    s_barrier
    s_waitcnt vmcnt(8)
    v_mov_b32 v22, 134192
    v_mov_b32 v23, 1
    s_mov_b64 exec, 1
    ds_add_u32 v22, v23
    s_mov_b64 exec, -1
L_a_qs0:
    ds_read_b32 v23, v22
    s_waitcnt lgkmcnt(0)
    v_readfirstlane_b32 s79, v23
    s_nop 0
    s_cmp_lt_u32 s79, 4
    s_cbranch_scc1 L_a_qs0
    ds_read_b64_tr_b16 v[80:81], v14 offset:0
    ds_read_b64_tr_b16 v[82:83], v14 offset:512
    ds_read_b64_tr_b16 v[84:85], v15 offset:0
    ds_read_b64_tr_b16 v[86:87], v15 offset:512
    ds_read_b64_tr_b16 v[88:89], v14 offset:4096
    ds_read_b64_tr_b16 v[90:91], v14 offset:4608
    ds_read_b64_tr_b16 v[92:93], v15 offset:4096
    ds_read_b64_tr_b16 v[94:95], v15 offset:4608
    s_waitcnt lgkmcnt(4)
    v_mfma_f32_32x32x16_bf16 v[48:63], v[80:83], v[112:115], 0
    ds_read_b64_tr_b16 v[96:97], v14 offset:8192
    ds_read_b64_tr_b16 v[98:99], v14 offset:8704
    v_mfma_f32_16x16x32_bf16 a[12:15], a[4:7], v[80:83], 0
    v_mfma_f32_32x32x16_bf16 v[48:63], v[84:87], v[116:119], v[48:63]
    ds_read_b64_tr_b16 v[100:101], v15 offset:8192
    ds_read_b64_tr_b16 v[102:103], v15 offset:8704
    s_waitcnt lgkmcnt(4)
    v_mfma_f32_32x32x16_bf16 v[48:63], v[88:91], v[120:123], v[48:63]
    ds_read_b64_tr_b16 v[104:105], v14 offset:12288
    ds_read_b64_tr_b16 v[106:107], v14 offset:12800
    v_mfma_f32_16x16x32_bf16 a[12:15], a[4:7], v[88:91], a[12:15]
    v_mfma_f32_32x32x16_bf16 v[48:63], v[92:95], v[124:127], v[48:63]
    ds_read_b64_tr_b16 v[108:109], v15 offset:12288
    ds_read_b64_tr_b16 v[110:111], v15 offset:12800
    s_waitcnt lgkmcnt(4)
    v_mfma_f32_32x32x16_bf16 v[48:63], v[96:99], v[128:131], v[48:63]
    ds_read_b64_tr_b16 v[80:81], v14 offset:16384
    ds_read_b64_tr_b16 v[82:83], v14 offset:16896
    v_mfma_f32_16x16x32_bf16 a[12:15], a[4:7], v[96:99], a[12:15]
    v_mfma_f32_32x32x16_bf16 v[48:63], v[100:103], v[132:135], v[48:63]
    ds_read_b64_tr_b16 v[84:85], v15 offset:16384
    ds_read_b64_tr_b16 v[86:87], v15 offset:16896
    s_waitcnt lgkmcnt(4)
    v_mfma_f32_32x32x16_bf16 v[48:63], v[104:107], v[136:139], v[48:63]
    ds_read_b64_tr_b16 v[88:89], v14 offset:20480
    ds_read_b64_tr_b16 v[90:91], v14 offset:20992
    v_mfma_f32_16x16x32_bf16 a[12:15], a[4:7], v[104:107], a[12:15]
    v_mfma_f32_32x32x16_bf16 v[48:63], v[108:111], v[140:143], v[48:63]
    ds_read_b64_tr_b16 v[92:93], v15 offset:20480
    ds_read_b64_tr_b16 v[94:95], v15 offset:20992
    s_waitcnt lgkmcnt(4)
    v_mfma_f32_32x32x16_bf16 v[48:63], v[80:83], v[144:147], v[48:63]
    ds_read_b64_tr_b16 v[96:97], v14 offset:24576
    ds_read_b64_tr_b16 v[98:99], v14 offset:25088
    v_mfma_f32_16x16x32_bf16 a[12:15], a[4:7], v[80:83], a[12:15]
    v_mfma_f32_32x32x16_bf16 v[48:63], v[84:87], v[148:151], v[48:63]
    ds_read_b64_tr_b16 v[100:101], v15 offset:24576
    ds_read_b64_tr_b16 v[102:103], v15 offset:25088
    s_waitcnt lgkmcnt(4)
    v_mfma_f32_32x32x16_bf16 v[48:63], v[88:91], v[152:155], v[48:63]
    ds_read_b64_tr_b16 v[104:105], v14 offset:28672
    ds_read_b64_tr_b16 v[106:107], v14 offset:29184
    v_mfma_f32_16x16x32_bf16 a[12:15], a[4:7], v[88:91], a[12:15]
    v_mfma_f32_32x32x16_bf16 v[48:63], v[92:95], v[156:159], v[48:63]
    s_waitcnt vmcnt(0)
    v_mov_b32 v22, 134196
    v_mov_b32 v23, 1
    s_mov_b64 exec, 1
    ds_add_u32 v22, v23
    s_mov_b64 exec, -1
L_a_qs1:
    ds_read_b32 v23, v22
    s_waitcnt lgkmcnt(0)
    v_readfirstlane_b32 s79, v23
    s_nop 0
    s_cmp_lt_u32 s79, 4
    s_cbranch_scc1 L_a_qs1
    ds_read_b64_tr_b16 v[108:109], v15 offset:28672
    ds_read_b64_tr_b16 v[110:111], v15 offset:29184
    v_mfma_f32_32x32x16_bf16 v[48:63], v[96:99], v[160:163], v[48:63]
    ds_read_b64_tr_b16 v[80:81], v14 offset:32768
    ds_read_b64_tr_b16 v[82:83], v14 offset:33280
    v_mfma_f32_16x16x32_bf16 a[12:15], a[4:7], v[96:99], a[12:15]
    v_mfma_f32_32x32x16_bf16 v[48:63], v[100:103], v[164:167], v[48:63]
    ds_read_b64_tr_b16 v[84:85], v15 offset:32768
    ds_read_b64_tr_b16 v[86:87], v15 offset:33280
    s_waitcnt lgkmcnt(4)
    v_mfma_f32_32x32x16_bf16 v[48:63], v[104:107], v[168:171], v[48:63]
    ds_read_b64_tr_b16 v[88:89], v14 offset:36864
    ds_read_b64_tr_b16 v[90:91], v14 offset:37376
    v_mfma_f32_16x16x32_bf16 a[12:15], a[4:7], v[104:107], a[12:15]
    v_mfma_f32_32x32x16_bf16 v[48:63], v[108:111], v[172:175], v[48:63]
    ds_read_b64_tr_b16 v[92:93], v15 offset:36864
    ds_read_b64_tr_b16 v[94:95], v15 offset:37376
    s_waitcnt lgkmcnt(4)
    v_mfma_f32_32x32x16_bf16 v[48:63], v[80:83], v[176:179], v[48:63]
    ds_read_b64_tr_b16 v[96:97], v14 offset:40960
    ds_read_b64_tr_b16 v[98:99], v14 offset:41472
    v_mfma_f32_16x16x32_bf16 a[12:15], a[4:7], v[80:83], a[12:15]
    v_mfma_f32_32x32x16_bf16 v[48:63], v[84:87], v[180:183], v[48:63]
    ds_read_b64_tr_b16 v[100:101], v15 offset:40960
    ds_read_b64_tr_b16 v[102:103], v15 offset:41472
    s_waitcnt lgkmcnt(4)
    v_mfma_f32_32x32x16_bf16 v[48:63], v[88:91], v[184:187], v[48:63]
    ds_read_b64_tr_b16 v[104:105], v14 offset:45056
    ds_read_b64_tr_b16 v[106:107], v14 offset:45568
    v_mfma_f32_16x16x32_bf16 a[12:15], a[4:7], v[88:91], a[12:15]
    v_mfma_f32_32x32x16_bf16 v[48:63], v[92:95], v[188:191], v[48:63]
    ds_read_b64_tr_b16 v[108:109], v15 offset:45056
    ds_read_b64_tr_b16 v[110:111], v15 offset:45568
    s_waitcnt lgkmcnt(4)
    v_mfma_f32_32x32x16_bf16 v[48:63], v[96:99], v[192:195], v[48:63]
    ds_read_b64_tr_b16 v[80:81], v14 offset:49152
    ds_read_b64_tr_b16 v[82:83], v14 offset:49664
    v_mfma_f32_16x16x32_bf16 a[12:15], a[4:7], v[96:99], a[12:15]
    v_mfma_f32_32x32x16_bf16 v[48:63], v[100:103], v[196:199], v[48:63]
    ds_read_b64_tr_b16 v[84:85], v15 offset:49152
    ds_read_b64_tr_b16 v[86:87], v15 offset:49664
    s_waitcnt lgkmcnt(4)
    v_mfma_f32_32x32x16_bf16 v[48:63], v[104:107], v[200:203], v[48:63]
    ds_read_b64_tr_b16 v[88:89], v14 offset:53248
    ds_read_b64_tr_b16 v[90:91], v14 offset:53760
    v_mfma_f32_16x16x32_bf16 a[12:15], a[4:7], v[104:107], a[12:15]
    v_mfma_f32_32x32x16_bf16 v[48:63], v[108:111], v[204:207], v[48:63]
    ds_read_b64_tr_b16 v[92:93], v15 offset:53248
    ds_read_b64_tr_b16 v[94:95], v15 offset:53760
    s_waitcnt lgkmcnt(4)
    v_mfma_f32_32x32x16_bf16 v[48:63], v[80:83], v[208:211], v[48:63]
    ds_read_b64_tr_b16 v[96:97], v14 offset:57344
    ds_read_b64_tr_b16 v[98:99], v14 offset:57856
    v_mfma_f32_16x16x32_bf16 a[12:15], a[4:7], v[80:83], a[12:15]
    v_mfma_f32_32x32x16_bf16 v[48:63], v[84:87], v[212:215], v[48:63]
    ds_read_b64_tr_b16 v[100:101], v15 offset:57344
    ds_read_b64_tr_b16 v[102:103], v15 offset:57856
    s_waitcnt lgkmcnt(4)
    v_mfma_f32_32x32x16_bf16 v[48:63], v[88:91], v[216:219], v[48:63]
    ds_read_b64_tr_b16 v[104:105], v14 offset:61440
    ds_read_b64_tr_b16 v[106:107], v14 offset:61952
    v_mfma_f32_16x16x32_bf16 a[12:15], a[4:7], v[88:91], a[12:15]
    v_mfma_f32_32x32x16_bf16 v[48:63], v[92:95], v[220:223], v[48:63]
    ds_read_b64_tr_b16 v[108:109], v15 offset:61440
    ds_read_b64_tr_b16 v[110:111], v15 offset:61952
    s_waitcnt lgkmcnt(4)
    v_mfma_f32_32x32x16_bf16 v[48:63], v[96:99], v[224:227], v[48:63]
    v_mfma_f32_16x16x32_bf16 a[12:15], a[4:7], v[96:99], a[12:15]
    v_mfma_f32_32x32x16_bf16 v[48:63], v[100:103], v[228:231], v[48:63]
    s_waitcnt lgkmcnt(0)
    v_mfma_f32_32x32x16_bf16 v[48:63], v[104:107], v[232:235], v[48:63]
    v_mfma_f32_16x16x32_bf16 a[12:15], a[4:7], v[104:107], a[12:15]
    v_mfma_f32_32x32x16_bf16 v[48:63], v[108:111], v[236:239], v[48:63]
    s_nop 6
    v_accvgpr_read_b32 v64, a12
    v_accvgpr_read_b32 v65, a13
    v_cndmask_b32 v64, v64, v65, s[82:83]
    v_add_u32 v65, s75, v0
    ds_write_b32 v65, v64 offset:1024
    s_add_u32 s40, s40, 32
    s_add_u32 s41, s41, 32
    v_mov_b32 v65, s40
    v_mov_b32 v66, 1
    ds_write_b32 v65, v66
    v_lshrrev_b32 v20, 5, v1
    v_lshlrev_b32 v20, 4, v20
    v_add_u32 v21, s76, v20
    v_add_u32 v20, s75, v20
    v_mov_b32 v65, s41
L_a_pw2:
    ds_read_b32 v66, v65
    s_waitcnt lgkmcnt(0)
    v_readfirstlane_b32 s79, v66
    s_nop 0
    s_cmp_eq_u32 s79, 0
    s_cbranch_scc1 L_a_pw2
    ds_read_b128 v[24:27], v20 offset:1024
    ds_read_b128 v[64:67], v21 offset:1024
    ds_read_b128 v[28:31], v20 offset:1056
    ds_read_b128 v[68:71], v21 offset:1056
    ds_read_b128 v[32:35], v20 offset:1088
    ds_read_b128 v[72:75], v21 offset:1088
    ds_read_b128 v[36:39], v20 offset:1120
    ds_read_b128 v[76:79], v21 offset:1120
    s_waitcnt lgkmcnt(6)
    v_add_f32 v24, v24, v64
    v_add_f32 v25, v25, v65
    v_add_f32 v26, v26, v66
    v_add_f32 v27, v27, v67
    s_waitcnt lgkmcnt(4)
    v_add_f32 v28, v28, v68
    v_add_f32 v29, v29, v69
    v_add_f32 v30, v30, v70
    v_add_f32 v31, v31, v71
    s_waitcnt lgkmcnt(2)
    v_add_f32 v32, v32, v72
    v_add_f32 v33, v33, v73
    v_add_f32 v34, v34, v74
    v_add_f32 v35, v35, v75
    s_waitcnt lgkmcnt(0)
    v_add_f32 v36, v36, v76
    v_add_f32 v37, v37, v77
    v_add_f32 v38, v38, v78
    v_add_f32 v39, v39, v79
    v_fma_f32 v48, -v2, v24, v48
    v_fma_f32 v49, -v2, v25, v49
    v_fma_f32 v48, v3, v48, s81
    v_fma_f32 v49, v3, v49, s81
    v_mul_f32 v22, 0x3fb8aa3b, v48
    v_mul_f32 v23, 0x3fb8aa3b, v49
    v_exp_f32_e64 v22, v22 clamp
    v_exp_f32_e64 v23, v23 clamp
    v_max_f32 v48, s81, v48
    v_max_f32 v49, s81, v49
    v_add_f32 v48, v48, v22
    v_add_f32 v49, v49, v23
    v_cvt_pk_bf16_f32 v48, v48, v49
    v_fma_f32 v50, -v2, v26, v50
    v_fma_f32 v51, -v2, v27, v51
    v_fma_f32 v50, v3, v50, s81
    v_fma_f32 v51, v3, v51, s81
    v_mul_f32 v22, 0x3fb8aa3b, v50
    v_mul_f32 v23, 0x3fb8aa3b, v51
    v_exp_f32_e64 v22, v22 clamp
    v_exp_f32_e64 v23, v23 clamp
    v_max_f32 v50, s81, v50
    v_max_f32 v51, s81, v51
    v_add_f32 v50, v50, v22
    v_add_f32 v51, v51, v23
    v_cvt_pk_bf16_f32 v49, v50, v51
    v_fma_f32 v52, -v2, v28, v52
    v_fma_f32 v53, -v2, v29, v53
    v_fma_f32 v52, v3, v52, s81
    v_fma_f32 v53, v3, v53, s81
    v_mul_f32 v22, 0x3fb8aa3b, v52
    v_mul_f32 v23, 0x3fb8aa3b, v53
    v_exp_f32_e64 v22, v22 clamp
    v_exp_f32_e64 v23, v23 clamp
    v_max_f32 v52, s81, v52
    v_max_f32 v53, s81, v53
    v_add_f32 v52, v52, v22
    v_add_f32 v53, v53, v23
    v_cvt_pk_bf16_f32 v50, v52, v53
    v_fma_f32 v54, -v2, v30, v54
    v_fma_f32 v55, -v2, v31, v55
    v_fma_f32 v54, v3, v54, s81
    v_fma_f32 v55, v3, v55, s81
    v_mul_f32 v22, 0x3fb8aa3b, v54
    v_mul_f32 v23, 0x3fb8aa3b, v55
    v_exp_f32_e64 v22, v22 clamp
    v_exp_f32_e64 v23, v23 clamp
    v_max_f32 v54, s81, v54
    v_max_f32 v55, s81, v55
    v_add_f32 v54, v54, v22
    v_add_f32 v55, v55, v23
    v_cvt_pk_bf16_f32 v51, v54, v55
    v_fma_f32 v56, -v2, v32, v56
    v_fma_f32 v57, -v2, v33, v57
    v_fma_f32 v56, v3, v56, s81
    v_fma_f32 v57, v3, v57, s81
    v_mul_f32 v22, 0x3fb8aa3b, v56
    v_mul_f32 v23, 0x3fb8aa3b, v57
    v_exp_f32_e64 v22, v22 clamp
    v_exp_f32_e64 v23, v23 clamp
    v_max_f32 v56, s81, v56
    v_max_f32 v57, s81, v57
    v_add_f32 v56, v56, v22
    v_add_f32 v57, v57, v23
    v_cvt_pk_bf16_f32 v52, v56, v57
    v_fma_f32 v58, -v2, v34, v58
    v_fma_f32 v59, -v2, v35, v59
    v_fma_f32 v58, v3, v58, s81
    v_fma_f32 v59, v3, v59, s81
    v_mul_f32 v22, 0x3fb8aa3b, v58
    v_mul_f32 v23, 0x3fb8aa3b, v59
    v_exp_f32_e64 v22, v22 clamp
    v_exp_f32_e64 v23, v23 clamp
    v_max_f32 v58, s81, v58
    v_max_f32 v59, s81, v59
    v_add_f32 v58, v58, v22
    v_add_f32 v59, v59, v23
    v_cvt_pk_bf16_f32 v53, v58, v59
    v_fma_f32 v60, -v2, v36, v60
    v_fma_f32 v61, -v2, v37, v61
    v_fma_f32 v60, v3, v60, s81
    v_fma_f32 v61, v3, v61, s81
    v_mul_f32 v22, 0x3fb8aa3b, v60
    v_mul_f32 v23, 0x3fb8aa3b, v61
    v_exp_f32_e64 v22, v22 clamp
    v_exp_f32_e64 v23, v23 clamp
    v_max_f32 v60, s81, v60
    v_max_f32 v61, s81, v61
    v_add_f32 v60, v60, v22
    v_add_f32 v61, v61, v23
    v_cvt_pk_bf16_f32 v54, v60, v61
    v_fma_f32 v62, -v2, v38, v62
    v_fma_f32 v63, -v2, v39, v63
    v_fma_f32 v62, v3, v62, s81
    v_fma_f32 v63, v3, v63, s81
    v_mul_f32 v22, 0x3fb8aa3b, v62
    v_mul_f32 v23, 0x3fb8aa3b, v63
    v_exp_f32_e64 v22, v22 clamp
    v_exp_f32_e64 v23, v23 clamp
    v_max_f32 v62, s81, v62
    v_max_f32 v63, s81, v63
    v_add_f32 v62, v62, v22
    v_add_f32 v63, v63, v23
    v_cvt_pk_bf16_f32 v55, v62, v63
    s_lshl_b32 s79, s32, 1
    s_add_u32 s79, s79, s29
    s_lshl_b32 s79, s79, 5
    s_lshl_b32 s80, s33, 2
    s_add_u32 s79, s79, s80
    s_lshl_b32 s80, s30, 1
    s_add_u32 s79, s79, s80
    s_lshl_b32 s79, s79, 10
    s_add_u32 s79, s79, 0x380000
    buffer_store_dwordx4 v[48:51], v7, s[12:15], s79 offen sc1
    buffer_store_dwordx4 v[52:55], v7, s[12:15], s79 offen offset:1024 sc1
    s_endpgm
.globl bcd_kernel
.p2align 8
.type bcd_kernel,@function
bcd_kernel:
    s_cmp_ge_u32 s2, 256
    s_cbranch_scc1 L_f_end
    s_load_dwordx2 s[4:5], s[0:1], 72
    s_load_dwordx2 s[8:9], s[0:1], 0
    s_load_dwordx2 s[12:13], s[0:1], 56
    s_mov_b32 s6, 0x1540000
    s_mov_b32 s7, 0x00020000
    s_mov_b32 s10, 0x200000
    s_mov_b32 s11, 0x00020000
    s_mov_b32 s14, 0x200000
    s_mov_b32 s15, 0x00020000
    v_and_b32 v1, 63, v0
    v_lshrrev_b32 v2, 6, v0
    s_nop 0
    v_readfirstlane_b32 s16, v2
    v_lshlrev_b32 v2, 4, v1
    v_add_u32 v3, 4096, v2
    s_and_b32 s24, s2, 7
    s_lshr_b32 s25, s2, 3
    s_getpc_b64 s[64:65]
L_f_pc:
    s_sub_u32 s64, s64, L_f_pc-bcd_kernel
    s_subb_u32 s65, s65, 0
    s_lshl_b32 s26, s25, 2
    s_add_u32 s26, s26, s16
    s_lshl_b32 s26, s26, 9
    v_lshlrev_b32 v8, 3, v1
    v_add_u32 v8, s26, v8
    v_min_u32 v8, L_text_end-bcd_kernel-4, v8
    global_load_dword v30, v8, s[64:65]
    s_and_b32 s17, s24, 1
    s_lshl_b32 s17, s17, 3
    s_and_b32 s26, s25, 7
    s_add_u32 s17, s17, s26
    s_lshr_b32 s18, s24, 1
    s_lshl_b32 s18, s18, 2
    s_lshr_b32 s26, s25, 3
    s_add_u32 s18, s18, s26
    s_lshl_b32 s19, s24, 2
    s_and_b32 s26, s25, 3
    s_add_u32 s19, s19, s26
    s_lshr_b32 s20, s25, 2
    s_lshl_b32 s21, s19, 1
    s_and_b32 s26, s16, 1
    s_add_u32 s21, s21, s26
    s_lshl_b32 s22, s20, 1
    s_lshr_b32 s26, s16, 1
    s_add_u32 s22, s22, s26
    s_lshl_b32 s23, s17, 2
    s_add_u32 s23, s23, s16
    s_lshl_b32 s27, s16, 3
    s_lshl_b32 s28, s19, 6
    s_add_u32 s28, s28, s27
    s_lshl_b32 s28, s28, 10
    s_add_u32 s28, s28, 0x380000
    s_and_b32 s26, s16, 1
    s_lshl_b32 s26, s26, 15
    s_add_u32 s29, s28, 32768
    s_sub_u32 s29, s29, s26
    s_add_u32 s28, s28, s26
    s_lshl_b32 s30, s27, 4
    s_lshl_b32 s26, s20, 1
    s_add_u32 s30, s30, s26
    s_lshl_b32 s30, s30, 10
    s_add_u32 s30, s30, 0x590000
    s_lshr_b32 s26, s16, 1
    s_lshl_b32 s26, s26, 10
    s_add_u32 s64, s30, 1024
    s_sub_u32 s64, s64, s26
    s_add_u32 s30, s30, s26
    s_lshl_b32 s31, s27, 11
    s_add_u32 s31, s31, 0x580000
    v_and_b32 v4, 31, v1
    v_min_u32 v5, 16, v4
    v_lshrrev_b32 v6, 5, v1
    v_mul_u32_u24 v7, 17, v6
    v_add_u32 v5, v5, v7
    v_lshlrev_b32 v5, 4, v5
    s_waitcnt lgkmcnt(0)
    s_add_u32 s38, s31, 0
    buffer_load_dwordx4 v[128:131], v5, s[4:7], s38 offen
    buffer_load_dwordx4 v[132:135], v5, s[4:7], s38 offen offset:544
    buffer_load_dwordx4 a[96:99], v2, s[4:7], s28 offen offset:0
    buffer_load_dwordx4 a[100:103], v2, s[4:7], s29 offen offset:0
    s_add_u32 s39, s30, 0
    s_add_u32 s65, s64, 0
    buffer_load_dwordx4 a[160:163], v2, s[4:7], s39 offen
    buffer_load_dwordx4 a[164:167], v2, s[4:7], s65 offen
    s_add_u32 s38, s31, 2048
    buffer_load_dwordx4 v[136:139], v5, s[4:7], s38 offen
    buffer_load_dwordx4 v[140:143], v5, s[4:7], s38 offen offset:544
    buffer_load_dwordx4 a[104:107], v2, s[4:7], s28 offen offset:1024
    buffer_load_dwordx4 a[108:111], v2, s[4:7], s29 offen offset:1024
    s_add_u32 s39, s30, 16384
    s_add_u32 s65, s64, 16384
    buffer_load_dwordx4 a[168:171], v2, s[4:7], s39 offen
    buffer_load_dwordx4 a[172:175], v2, s[4:7], s65 offen
    s_add_u32 s38, s31, 4096
    buffer_load_dwordx4 v[144:147], v5, s[4:7], s38 offen
    buffer_load_dwordx4 v[148:151], v5, s[4:7], s38 offen offset:544
    buffer_load_dwordx4 a[112:115], v2, s[4:7], s28 offen offset:2048
    buffer_load_dwordx4 a[116:119], v2, s[4:7], s29 offen offset:2048
    s_add_u32 s39, s30, 32768
    s_add_u32 s65, s64, 32768
    buffer_load_dwordx4 a[176:179], v2, s[4:7], s39 offen
    buffer_load_dwordx4 a[180:183], v2, s[4:7], s65 offen
    s_lshl_b32 s32, s21, 15
    s_lshl_b32 s26, s22, 6
    s_add_u32 s32, s32, s26
    v_lshlrev_b32 v7, 10, v4
    v_lshlrev_b32 v8, 3, v6
    v_add_u32 v7, v7, v8
    s_mul_i32 s33, s18, 229376
    s_lshl_b32 s34, s16, 13
    s_add_u32 s33, s33, s34
    s_add_u32 s33, s33, 0x810000
    s_mul_i32 s35, s16, 28672
    s_mul_i32 s36, s20, 229376
    s_add_u32 s36, s36, s35
    s_add_u32 s36, s36, 0x12e0000
    s_lshr_b32 s26, s16, 1
    s_mul_i32 s26, s26, 114688
    s_add_u32 s37, s36, 114688
    s_sub_u32 s37, s37, s26
    s_add_u32 s36, s36, s26
    s_mul_i32 s50, s19, 229376
    s_add_u32 s50, s50, s35
    s_add_u32 s50, s50, 0xbe0000
    s_and_b32 s26, s16, 1
    s_mul_i32 s26, s26, 114688
    s_add_u32 s51, s50, 114688
    s_sub_u32 s51, s51, s26
    s_add_u32 s50, s50, s26
    s_mov_b32 s26, 0
    s_add_u32 s70, s36, s26
    s_add_u32 s74, s37, s26
    s_add_u32 s78, s50, s26
    s_add_u32 s82, s51, s26
    s_mov_b32 s26, 7168
    s_add_u32 s71, s36, s26
    s_add_u32 s75, s37, s26
    s_add_u32 s79, s50, s26
    s_add_u32 s83, s51, s26
    s_mov_b32 s26, 14336
    s_add_u32 s72, s36, s26
    s_add_u32 s76, s37, s26
    s_add_u32 s80, s50, s26
    s_add_u32 s84, s51, s26
    s_mov_b32 s26, 21504
    s_add_u32 s73, s36, s26
    s_add_u32 s77, s37, s26
    s_add_u32 s81, s50, s26
    s_add_u32 s85, s51, s26
    s_lshl_b32 s44, s17, 4
    s_add_u32 s44, s44, s18
    s_lshl_b32 s44, s44, 7
    s_add_u32 s44, s44, 0x14e0000
    s_and_b32 s26, s19, 1
    s_lshl_b32 s26, s26, 3
    s_add_u32 s26, s26, s20
    s_lshr_b32 s57, s19, 1
    s_lshl_b32 s62, s57, 11
    s_lshl_b32 s63, s26, 2
    s_add_u32 s62, s62, s63
    s_add_u32 s62, s62, 0x14e0000
    s_lshl_b32 s57, s57, 4
    s_add_u32 s57, s57, s26
    s_lshl_b32 s57, s57, 7
    s_add_u32 s57, s57, 0x14e8000
    s_lshl_b32 s63, s17, 11
    s_lshl_b32 s26, s18, 2
    s_add_u32 s63, s63, s26
    s_add_u32 s63, s63, 0x14e8000
    s_waitcnt vmcnt(17)
    v_cvt_pk_bf16_f32 v40, v128, v129
    v_cvt_pk_bf16_f32 v41, v130, v131
    s_waitcnt vmcnt(16)
    v_cvt_pk_bf16_f32 v42, v132, v133
    v_cvt_pk_bf16_f32 v43, v134, v135
    s_waitcnt vmcnt(15)
    s_nop 0
    v_mfma_f32_32x32x16_bf16 v[64:79], v[40:43], a[96:99], 0
    s_waitcnt vmcnt(14)
    v_mfma_f32_32x32x16_bf16 v[80:95], v[40:43], a[100:103], 0
    s_waitcnt vmcnt(11)
    v_cvt_pk_bf16_f32 v44, v136, v137
    v_cvt_pk_bf16_f32 v45, v138, v139
    s_waitcnt vmcnt(10)
    v_cvt_pk_bf16_f32 v46, v140, v141
    v_cvt_pk_bf16_f32 v47, v142, v143
    s_waitcnt vmcnt(9)
    s_nop 0
    v_mfma_f32_32x32x16_bf16 v[96:111], v[44:47], a[104:107], 0
    s_add_u32 s38, s31, 6144
    s_waitcnt vmcnt(8)
    v_mfma_f32_32x32x16_bf16 v[112:127], v[44:47], a[108:111], 0
    v_add_f32 v36, 0x358637bd, v72
    v_add_f32 v37, 0x358637bd, v88
    v_rcp_f32 v36, v36
    buffer_load_dwordx4 v[152:155], v5, s[4:7], s38 offen
    v_rcp_f32 v37, v37
    v_mul_f32 v64, v36, v64
    v_mul_f32 v80, v37, v80
    v_mul_f32 v65, v36, v65
    buffer_load_dwordx4 v[156:159], v5, s[4:7], s38 offen offset:544
    v_mul_f32 v81, v37, v81
    v_mul_f32 v66, v36, v66
    v_mul_f32 v82, v37, v82
    v_mul_f32 v67, v36, v67
    buffer_load_dwordx4 a[120:123], v2, s[4:7], s28 offen offset:3072
    v_mul_f32 v83, v37, v83
    v_mul_f32 v68, v36, v68
    v_mul_f32 v84, v37, v84
    v_mul_f32 v69, v36, v69
    v_mul_f32 v85, v37, v85
    buffer_load_dwordx4 a[124:127], v2, s[4:7], s29 offen offset:3072
    v_mul_f32 v70, v36, v70
    v_mul_f32 v86, v37, v86
    v_mul_f32 v71, v36, v71
    v_mul_f32 v87, v37, v87
    s_add_u32 s39, s30, 49152
    v_cvt_pk_bf16_f32 v48, v64, v65
    v_cvt_pk_bf16_f32 v49, v66, v67
    v_cvt_pk_bf16_f32 v50, v68, v69
    v_cvt_pk_bf16_f32 v51, v70, v71
    s_add_u32 s65, s64, 49152
    v_cvt_pk_bf16_f32 v52, v80, v81
    v_cvt_pk_bf16_f32 v53, v82, v83
    v_cvt_pk_bf16_f32 v54, v84, v85
    v_cvt_pk_bf16_f32 v55, v86, v87
    buffer_load_dwordx4 a[184:187], v2, s[4:7], s39 offen
    v_mfma_f32_32x32x16_bf16 v[192:207], a[160:163], v[48:51], 0
    v_mfma_f32_32x32x16_bf16 v[208:223], a[160:163], v[52:55], 0
    v_mfma_f32_32x32x16_bf16 v[224:239], a[164:167], v[48:51], 0
    v_mfma_f32_32x32x16_bf16 v[240:255], a[164:167], v[52:55], 0
    buffer_load_dwordx4 a[188:191], v2, s[4:7], s65 offen
    s_waitcnt vmcnt(11)
    v_cvt_pk_bf16_f32 v40, v144, v145
    v_cvt_pk_bf16_f32 v41, v146, v147
    s_waitcnt vmcnt(10)
    v_cvt_pk_bf16_f32 v42, v148, v149
    v_cvt_pk_bf16_f32 v43, v150, v151
    s_waitcnt vmcnt(9)
    s_nop 0
    v_mfma_f32_32x32x16_bf16 v[64:79], v[40:43], a[112:115], 0
    s_add_u32 s38, s31, 8192
    s_waitcnt vmcnt(8)
    v_mfma_f32_32x32x16_bf16 v[80:95], v[40:43], a[116:119], 0
    v_add_f32 v36, 0x358637bd, v104
    v_add_f32 v37, 0x358637bd, v120
    v_rcp_f32 v36, v36
    buffer_load_dwordx4 v[160:163], v5, s[4:7], s38 offen
    v_rcp_f32 v37, v37
    v_mul_f32 v96, v36, v96
    v_mul_f32 v112, v37, v112
    v_mul_f32 v97, v36, v97
    buffer_load_dwordx4 v[164:167], v5, s[4:7], s38 offen offset:544
    v_mul_f32 v113, v37, v113
    v_mul_f32 v98, v36, v98
    v_mul_f32 v114, v37, v114
    v_mul_f32 v99, v36, v99
    buffer_load_dwordx4 a[128:131], v3, s[4:7], s28 offen offset:0
    v_mul_f32 v115, v37, v115
    v_mul_f32 v100, v36, v100
    v_mul_f32 v116, v37, v116
    v_mul_f32 v101, v36, v101
    v_mul_f32 v117, v37, v117
    buffer_load_dwordx4 a[132:135], v3, s[4:7], s29 offen offset:0
    v_mul_f32 v102, v36, v102
    v_mul_f32 v118, v37, v118
    v_mul_f32 v103, v36, v103
    v_mul_f32 v119, v37, v119
    s_add_u32 s39, s30, 65536
    v_cvt_pk_bf16_f32 v48, v96, v97
    v_cvt_pk_bf16_f32 v49, v98, v99
    v_cvt_pk_bf16_f32 v50, v100, v101
    v_cvt_pk_bf16_f32 v51, v102, v103
    s_add_u32 s65, s64, 65536
    v_cvt_pk_bf16_f32 v52, v112, v113
    v_cvt_pk_bf16_f32 v53, v114, v115
    v_cvt_pk_bf16_f32 v54, v116, v117
    v_cvt_pk_bf16_f32 v55, v118, v119
    buffer_load_dwordx4 a[192:195], v2, s[4:7], s39 offen
    v_mfma_f32_32x32x16_bf16 v[192:207], a[168:171], v[48:51], v[192:207]
    v_mfma_f32_32x32x16_bf16 v[208:223], a[168:171], v[52:55], v[208:223]
    v_mfma_f32_32x32x16_bf16 v[224:239], a[172:175], v[48:51], v[224:239]
    v_mfma_f32_32x32x16_bf16 v[240:255], a[172:175], v[52:55], v[240:255]
    buffer_load_dwordx4 a[196:199], v2, s[4:7], s65 offen
    s_waitcnt vmcnt(11)
    v_cvt_pk_bf16_f32 v44, v152, v153
    v_cvt_pk_bf16_f32 v45, v154, v155
    s_waitcnt vmcnt(10)
    v_cvt_pk_bf16_f32 v46, v156, v157
    v_cvt_pk_bf16_f32 v47, v158, v159
    s_waitcnt vmcnt(9)
    s_nop 0
    v_mfma_f32_32x32x16_bf16 v[96:111], v[44:47], a[120:123], 0
    s_add_u32 s38, s31, 10240
    s_waitcnt vmcnt(8)
    v_mfma_f32_32x32x16_bf16 v[112:127], v[44:47], a[124:127], 0
    v_add_f32 v36, 0x358637bd, v72
    v_add_f32 v37, 0x358637bd, v88
    v_rcp_f32 v36, v36
    buffer_load_dwordx4 v[168:171], v5, s[4:7], s38 offen
    v_rcp_f32 v37, v37
    v_mul_f32 v64, v36, v64
    v_mul_f32 v80, v37, v80
    v_mul_f32 v65, v36, v65
    buffer_load_dwordx4 v[172:175], v5, s[4:7], s38 offen offset:544
    v_mul_f32 v81, v37, v81
    v_mul_f32 v66, v36, v66
    v_mul_f32 v82, v37, v82
    v_mul_f32 v67, v36, v67
    buffer_load_dwordx4 a[136:139], v3, s[4:7], s28 offen offset:1024
    v_mul_f32 v83, v37, v83
    v_mul_f32 v68, v36, v68
    v_mul_f32 v84, v37, v84
    v_mul_f32 v69, v36, v69
    v_mul_f32 v85, v37, v85
    buffer_load_dwordx4 a[140:143], v3, s[4:7], s29 offen offset:1024
    v_mul_f32 v70, v36, v70
    v_mul_f32 v86, v37, v86
    v_mul_f32 v71, v36, v71
    v_mul_f32 v87, v37, v87
    s_add_u32 s39, s30, 81920
    v_cvt_pk_bf16_f32 v48, v64, v65
    v_cvt_pk_bf16_f32 v49, v66, v67
    v_cvt_pk_bf16_f32 v50, v68, v69
    v_cvt_pk_bf16_f32 v51, v70, v71
    s_add_u32 s65, s64, 81920
    v_cvt_pk_bf16_f32 v52, v80, v81
    v_cvt_pk_bf16_f32 v53, v82, v83
    v_cvt_pk_bf16_f32 v54, v84, v85
    v_cvt_pk_bf16_f32 v55, v86, v87
    buffer_load_dwordx4 a[200:203], v2, s[4:7], s39 offen
    v_mfma_f32_32x32x16_bf16 v[192:207], a[176:179], v[48:51], v[192:207]
    v_mfma_f32_32x32x16_bf16 v[208:223], a[176:179], v[52:55], v[208:223]
    v_mfma_f32_32x32x16_bf16 v[224:239], a[180:183], v[48:51], v[224:239]
    v_mfma_f32_32x32x16_bf16 v[240:255], a[180:183], v[52:55], v[240:255]
    buffer_load_dwordx4 a[204:207], v2, s[4:7], s65 offen
    s_waitcnt vmcnt(11)
    v_cvt_pk_bf16_f32 v40, v160, v161
    v_cvt_pk_bf16_f32 v41, v162, v163
    s_waitcnt vmcnt(10)
    v_cvt_pk_bf16_f32 v42, v164, v165
    v_cvt_pk_bf16_f32 v43, v166, v167
    s_waitcnt vmcnt(9)
    s_nop 0
    v_mfma_f32_32x32x16_bf16 v[64:79], v[40:43], a[128:131], 0
    s_add_u32 s38, s31, 12288
    s_waitcnt vmcnt(8)
    v_mfma_f32_32x32x16_bf16 v[80:95], v[40:43], a[132:135], 0
    v_add_f32 v36, 0x358637bd, v104
    v_add_f32 v37, 0x358637bd, v120
    v_rcp_f32 v36, v36
    buffer_load_dwordx4 v[176:179], v5, s[4:7], s38 offen
    v_rcp_f32 v37, v37
    v_mul_f32 v96, v36, v96
    v_mul_f32 v112, v37, v112
    v_mul_f32 v97, v36, v97
    buffer_load_dwordx4 v[180:183], v5, s[4:7], s38 offen offset:544
    v_mul_f32 v113, v37, v113
    v_mul_f32 v98, v36, v98
    v_mul_f32 v114, v37, v114
    v_mul_f32 v99, v36, v99
    buffer_load_dwordx4 a[144:147], v3, s[4:7], s28 offen offset:2048
    v_mul_f32 v115, v37, v115
    v_mul_f32 v100, v36, v100
    v_mul_f32 v116, v37, v116
    v_mul_f32 v101, v36, v101
    v_mul_f32 v117, v37, v117
    buffer_load_dwordx4 a[148:151], v3, s[4:7], s29 offen offset:2048
    v_mul_f32 v102, v36, v102
    v_mul_f32 v118, v37, v118
    v_mul_f32 v103, v36, v103
    v_mul_f32 v119, v37, v119
    s_add_u32 s39, s30, 98304
    v_cvt_pk_bf16_f32 v48, v96, v97
    v_cvt_pk_bf16_f32 v49, v98, v99
    v_cvt_pk_bf16_f32 v50, v100, v101
    v_cvt_pk_bf16_f32 v51, v102, v103
    s_add_u32 s65, s64, 98304
    v_cvt_pk_bf16_f32 v52, v112, v113
    v_cvt_pk_bf16_f32 v53, v114, v115
    v_cvt_pk_bf16_f32 v54, v116, v117
    v_cvt_pk_bf16_f32 v55, v118, v119
    buffer_load_dwordx4 a[208:211], v2, s[4:7], s39 offen
    v_mfma_f32_32x32x16_bf16 v[192:207], a[184:187], v[48:51], v[192:207]
    v_mfma_f32_32x32x16_bf16 v[208:223], a[184:187], v[52:55], v[208:223]
    v_mfma_f32_32x32x16_bf16 v[224:239], a[188:191], v[48:51], v[224:239]
    v_mfma_f32_32x32x16_bf16 v[240:255], a[188:191], v[52:55], v[240:255]
    buffer_load_dwordx4 a[212:215], v2, s[4:7], s65 offen
    s_waitcnt vmcnt(11)
    v_cvt_pk_bf16_f32 v44, v168, v169
    v_cvt_pk_bf16_f32 v45, v170, v171
    s_waitcnt vmcnt(10)
    v_cvt_pk_bf16_f32 v46, v172, v173
    v_cvt_pk_bf16_f32 v47, v174, v175
    s_waitcnt vmcnt(9)
    s_nop 0
    v_mfma_f32_32x32x16_bf16 v[96:111], v[44:47], a[136:139], 0
    s_add_u32 s38, s31, 14336
    s_waitcnt vmcnt(8)
    v_mfma_f32_32x32x16_bf16 v[112:127], v[44:47], a[140:143], 0
    v_add_f32 v36, 0x358637bd, v72
    v_add_f32 v37, 0x358637bd, v88
    v_rcp_f32 v36, v36
    buffer_load_dwordx4 v[184:187], v5, s[4:7], s38 offen
    v_rcp_f32 v37, v37
    v_mul_f32 v64, v36, v64
    v_mul_f32 v80, v37, v80
    v_mul_f32 v65, v36, v65
    buffer_load_dwordx4 v[188:191], v5, s[4:7], s38 offen offset:544
    v_mul_f32 v81, v37, v81
    v_mul_f32 v66, v36, v66
    v_mul_f32 v82, v37, v82
    v_mul_f32 v67, v36, v67
    buffer_load_dwordx4 a[152:155], v3, s[4:7], s28 offen offset:3072
    v_mul_f32 v83, v37, v83
    v_mul_f32 v68, v36, v68
    v_mul_f32 v84, v37, v84
    v_mul_f32 v69, v36, v69
    v_mul_f32 v85, v37, v85
    buffer_load_dwordx4 a[156:159], v3, s[4:7], s29 offen offset:3072
    v_mul_f32 v70, v36, v70
    v_mul_f32 v86, v37, v86
    v_mul_f32 v71, v36, v71
    v_mul_f32 v87, v37, v87
    s_add_u32 s39, s30, 114688
    v_cvt_pk_bf16_f32 v48, v64, v65
    v_cvt_pk_bf16_f32 v49, v66, v67
    v_cvt_pk_bf16_f32 v50, v68, v69
    v_cvt_pk_bf16_f32 v51, v70, v71
    s_add_u32 s65, s64, 114688
    v_cvt_pk_bf16_f32 v52, v80, v81
    v_cvt_pk_bf16_f32 v53, v82, v83
    v_cvt_pk_bf16_f32 v54, v84, v85
    v_cvt_pk_bf16_f32 v55, v86, v87
    buffer_load_dwordx4 a[216:219], v2, s[4:7], s39 offen
    v_mfma_f32_32x32x16_bf16 v[192:207], a[192:195], v[48:51], v[192:207]
    v_mfma_f32_32x32x16_bf16 v[208:223], a[192:195], v[52:55], v[208:223]
    v_mfma_f32_32x32x16_bf16 v[224:239], a[196:199], v[48:51], v[224:239]
    v_mfma_f32_32x32x16_bf16 v[240:255], a[196:199], v[52:55], v[240:255]
    buffer_load_dwordx4 a[220:223], v2, s[4:7], s65 offen
    s_waitcnt vmcnt(11)
    v_cvt_pk_bf16_f32 v40, v176, v177
    v_cvt_pk_bf16_f32 v41, v178, v179
    s_waitcnt vmcnt(10)
    v_cvt_pk_bf16_f32 v42, v180, v181
    v_cvt_pk_bf16_f32 v43, v182, v183
    s_waitcnt vmcnt(9)
    s_nop 0
    v_mfma_f32_32x32x16_bf16 v[64:79], v[40:43], a[144:147], 0
    s_waitcnt vmcnt(8)
    v_mfma_f32_32x32x16_bf16 v[80:95], v[40:43], a[148:151], 0
    v_add_f32 v36, 0x358637bd, v104
    v_add_f32 v37, 0x358637bd, v120
    v_rcp_f32 v36, v36
    v_rcp_f32 v37, v37
    buffer_load_dwordx2 v[56:57], v7, s[8:11], s32 offen offset:0
    v_mul_f32 v96, v36, v96
    v_mul_f32 v112, v37, v112
    v_mul_f32 v97, v36, v97
    v_mul_f32 v113, v37, v113
    v_mul_f32 v98, v36, v98
    v_mul_f32 v114, v37, v114
    v_mul_f32 v99, v36, v99
    v_mul_f32 v115, v37, v115
    v_mul_f32 v100, v36, v100
    buffer_load_dwordx2 v[58:59], v7, s[8:11], s32 offen offset:16
    v_mul_f32 v116, v37, v116
    v_mul_f32 v101, v36, v101
    v_mul_f32 v117, v37, v117
    v_mul_f32 v102, v36, v102
    v_mul_f32 v118, v37, v118
    v_mul_f32 v103, v36, v103
    v_mul_f32 v119, v37, v119
    v_cvt_pk_bf16_f32 v48, v96, v97
    v_cvt_pk_bf16_f32 v49, v98, v99
    v_cvt_pk_bf16_f32 v50, v100, v101
    buffer_load_dwordx2 v[60:61], v7, s[8:11], s32 offen offset:32
    v_cvt_pk_bf16_f32 v51, v102, v103
    v_cvt_pk_bf16_f32 v52, v112, v113
    v_cvt_pk_bf16_f32 v53, v114, v115
    v_cvt_pk_bf16_f32 v54, v116, v117
    v_cvt_pk_bf16_f32 v55, v118, v119
    v_mfma_f32_32x32x16_bf16 v[192:207], a[200:203], v[48:51], v[192:207]
    s_nop 0
    v_mfma_f32_32x32x16_bf16 v[208:223], a[200:203], v[52:55], v[208:223]
    v_mfma_f32_32x32x16_bf16 v[224:239], a[204:207], v[48:51], v[224:239]
    v_mfma_f32_32x32x16_bf16 v[240:255], a[204:207], v[52:55], v[240:255]
    buffer_load_dwordx2 v[62:63], v7, s[8:11], s32 offen offset:48
    s_waitcnt vmcnt(9)
    v_cvt_pk_bf16_f32 v44, v184, v185
    v_cvt_pk_bf16_f32 v45, v186, v187
    s_waitcnt vmcnt(8)
    v_cvt_pk_bf16_f32 v46, v188, v189
    v_cvt_pk_bf16_f32 v47, v190, v191
    s_waitcnt vmcnt(7)
    s_nop 0
    v_mfma_f32_32x32x16_bf16 v[96:111], v[44:47], a[152:155], 0
    s_waitcnt vmcnt(6)
    v_mfma_f32_32x32x16_bf16 v[112:127], v[44:47], a[156:159], 0
    v_add_f32 v36, 0x358637bd, v72
    v_add_f32 v37, 0x358637bd, v88
    v_rcp_f32 v36, v36
    v_rcp_f32 v37, v37
    v_mul_f32 v64, v36, v64
    v_mul_f32 v80, v37, v80
    v_mul_f32 v65, v36, v65
    v_mul_f32 v81, v37, v81
    v_mul_f32 v66, v36, v66
    v_mul_f32 v82, v37, v82
    v_mul_f32 v67, v36, v67
    v_mul_f32 v83, v37, v83
    v_mul_f32 v68, v36, v68
    v_mul_f32 v84, v37, v84
    v_mul_f32 v69, v36, v69
    v_mul_f32 v85, v37, v85
    v_mul_f32 v70, v36, v70
    v_mul_f32 v86, v37, v86
    v_mul_f32 v71, v36, v71
    v_mul_f32 v87, v37, v87
    v_cvt_pk_bf16_f32 v48, v64, v65
    v_cvt_pk_bf16_f32 v49, v66, v67
    v_cvt_pk_bf16_f32 v50, v68, v69
    v_cvt_pk_bf16_f32 v51, v70, v71
    v_cvt_pk_bf16_f32 v52, v80, v81
    v_cvt_pk_bf16_f32 v53, v82, v83
    v_cvt_pk_bf16_f32 v54, v84, v85
    v_cvt_pk_bf16_f32 v55, v86, v87
    v_mfma_f32_32x32x16_bf16 v[192:207], a[208:211], v[48:51], v[192:207]
    s_nop 0
    v_mfma_f32_32x32x16_bf16 v[208:223], a[208:211], v[52:55], v[208:223]
    v_mfma_f32_32x32x16_bf16 v[224:239], a[212:215], v[48:51], v[224:239]
    v_mfma_f32_32x32x16_bf16 v[240:255], a[212:215], v[52:55], v[240:255]
    v_add_f32 v36, 0x358637bd, v104
    v_add_f32 v37, 0x358637bd, v120
    v_rcp_f32 v36, v36
    v_rcp_f32 v37, v37
    v_mul_f32 v96, v36, v96
    v_mul_f32 v112, v37, v112
    v_mul_f32 v97, v36, v97
    v_mul_f32 v113, v37, v113
    v_mul_f32 v98, v36, v98
    v_mul_f32 v114, v37, v114
    v_mul_f32 v99, v36, v99
    v_mul_f32 v115, v37, v115
    v_mul_f32 v100, v36, v100
    v_mul_f32 v116, v37, v116
    v_mul_f32 v101, v36, v101
    v_mul_f32 v117, v37, v117
    v_mul_f32 v102, v36, v102
    v_mul_f32 v118, v37, v118
    v_mul_f32 v103, v36, v103
    v_mul_f32 v119, v37, v119
    v_cvt_pk_bf16_f32 v48, v96, v97
    v_cvt_pk_bf16_f32 v49, v98, v99
    v_cvt_pk_bf16_f32 v50, v100, v101
    v_cvt_pk_bf16_f32 v51, v102, v103
    v_cvt_pk_bf16_f32 v52, v112, v113
    v_cvt_pk_bf16_f32 v53, v114, v115
    v_cvt_pk_bf16_f32 v54, v116, v117
    v_cvt_pk_bf16_f32 v55, v118, v119
    s_waitcnt vmcnt(5)
    v_mfma_f32_32x32x16_bf16 v[192:207], a[216:219], v[48:51], v[192:207]
    v_mfma_f32_32x32x16_bf16 v[208:223], a[216:219], v[52:55], v[208:223]
    s_waitcnt vmcnt(4)
    v_mfma_f32_32x32x16_bf16 v[224:239], a[220:223], v[48:51], v[224:239]
    v_mfma_f32_32x32x16_bf16 v[240:255], a[220:223], v[52:55], v[240:255]
    s_mul_i32 s38, s16, 12288
    s_add_u32 s38, s38, 98304
    v_add_u32 v10, s38, v2
    s_nop 5
    ds_write_b128 v10, v[208:211] offset:0
    ds_write_b128 v10, v[212:215] offset:1024
    ds_write_b128 v10, v[216:219] offset:2048
    s_mov_b32 s42, s34
    ds_write_b128 v10, v[220:223] offset:3072
    ds_write_b128 v10, v[224:227] offset:4096
    ds_write_b128 v10, v[228:231] offset:5120
    ds_write_b128 v10, v[232:235] offset:6144
    ds_write_b128 v10, v[236:239] offset:7168
    ds_write_b128 v10, v[240:243] offset:8192
    s_add_u32 m0, s42, 0
    ds_write_b128 v10, v[244:247] offset:9216
    ds_write_b128 v10, v[248:251] offset:10240
    ds_write_b128 v10, v[252:255] offset:11264
    s_xor_b32 s38, s16, 1
    s_mul_i32 s38, s38, 12288
    s_add_u32 s40, s33, 0
    s_add_u32 s38, s38, 98304
    v_add_u32 v41, s38, v2
    s_xor_b32 s38, s16, 2
    s_mul_i32 s38, s38, 12288
    s_add_u32 s38, s38, 102400
    v_add_u32 v42, s38, v2
    buffer_load_dwordx4 v2, s[4:7], s40 offen offset:0 lds
    s_xor_b32 s38, s16, 3
    s_mul_i32 s38, s38, 12288
    s_add_u32 s38, s38, 106496
    v_add_u32 v43, s38, v2
    s_waitcnt vmcnt(4)
    v_lshlrev_b32 v64, 16, v56
    buffer_load_dwordx4 v2, s[4:7], s40 offen offset:1024 lds
    v_and_b32 v65, 0xffff0000, v56
    v_lshlrev_b32 v66, 16, v57
    v_and_b32 v67, 0xffff0000, v57
    s_waitcnt vmcnt(4)
    v_lshlrev_b32 v68, 16, v58
    v_and_b32 v69, 0xffff0000, v58
    v_lshlrev_b32 v70, 16, v59
    buffer_load_dwordx4 v2, s[4:7], s40 offen offset:2048 lds
    v_and_b32 v71, 0xffff0000, v59
    s_waitcnt vmcnt(4)
    v_lshlrev_b32 v72, 16, v60
    v_and_b32 v73, 0xffff0000, v60
    v_lshlrev_b32 v74, 16, v61
    v_and_b32 v75, 0xffff0000, v61
    buffer_load_dwordx4 v2, s[4:7], s40 offen offset:3072 lds
    s_waitcnt vmcnt(4)
    v_lshlrev_b32 v76, 16, v62
    v_and_b32 v77, 0xffff0000, v62
    v_lshlrev_b32 v78, 16, v63
    v_and_b32 v79, 0xffff0000, v63
    v_add_f32 v192, v192, v64
    v_add_f32 v193, v193, v65
    s_add_u32 m0, s42, 4096
    v_add_f32 v194, v194, v66
    v_add_f32 v195, v195, v67
    v_add_f32 v196, v196, v68
    v_add_f32 v197, v197, v69
    v_add_f32 v198, v198, v70
    s_add_u32 s40, s33, 4096
    v_add_f32 v199, v199, v71
    v_add_f32 v200, v200, v72
    v_add_f32 v201, v201, v73
    v_add_f32 v202, v202, v74
    v_add_f32 v203, v203, v75
    v_add_f32 v204, v204, v76
    buffer_load_dwordx4 v2, s[4:7], s40 offen offset:0 lds
    v_add_f32 v205, v205, v77
    v_add_f32 v206, v206, v78
    v_add_f32 v207, v207, v79
    s_waitcnt lgkmcnt(0)
    s_barrier
    buffer_load_dwordx4 v2, s[4:7], s40 offen offset:1024 lds
    ds_read_b128 v[208:211], v41 offset:0
    ds_read_b128 v[212:215], v41 offset:1024
    ds_read_b128 v[216:219], v41 offset:2048
    ds_read_b128 v[220:223], v41 offset:3072
    ds_read_b128 v[224:227], v42 offset:0
    ds_read_b128 v[228:231], v42 offset:1024
    buffer_load_dwordx4 v2, s[4:7], s40 offen offset:2048 lds
    ds_read_b128 v[232:235], v42 offset:2048
    ds_read_b128 v[236:239], v42 offset:3072
    ds_read_b128 v[240:243], v43 offset:0
    ds_read_b128 v[244:247], v43 offset:1024
    ds_read_b128 v[248:251], v43 offset:2048
    buffer_load_dwordx4 v2, s[4:7], s40 offen offset:3072 lds
    ds_read_b128 v[252:255], v43 offset:3072
    s_waitcnt lgkmcnt(11)
    v_add_f32 v192, v192, v208
    v_add_f32 v193, v193, v209
    v_add_f32 v194, v194, v210
    v_add_f32 v195, v195, v211
    s_waitcnt lgkmcnt(10)
    v_add_f32 v196, v196, v212
    s_add_u32 s43, s33, 32768
    v_add_f32 v197, v197, v213
    v_add_f32 v198, v198, v214
    v_add_f32 v199, v199, v215
    s_waitcnt lgkmcnt(9)
    v_add_f32 v200, v200, v216
    v_add_f32 v201, v201, v217
    s_add_u32 s42, s34, 32768
    v_add_f32 v202, v202, v218
    v_add_f32 v203, v203, v219
    s_waitcnt lgkmcnt(8)
    v_add_f32 v204, v204, v220
    v_add_f32 v205, v205, v221
    v_add_f32 v206, v206, v222
    v_add_f32 v207, v207, v223
    s_add_u32 m0, s42, 0
    s_waitcnt lgkmcnt(3)
    v_add_f32 v224, v224, v240
    v_add_f32 v225, v225, v241
    v_add_f32 v226, v226, v242
    v_add_f32 v227, v227, v243
    s_waitcnt lgkmcnt(2)
    v_add_f32 v228, v228, v244
    s_add_u32 s40, s43, 0
    v_add_f32 v229, v229, v245
    v_add_f32 v230, v230, v246
    v_add_f32 v231, v231, v247
    s_waitcnt lgkmcnt(1)
    v_add_f32 v232, v232, v248
    v_add_f32 v233, v233, v249
    v_add_f32 v234, v234, v250
    buffer_load_dwordx4 v2, s[4:7], s40 offen offset:0 lds
    v_add_f32 v235, v235, v251
    s_waitcnt lgkmcnt(0)
    v_add_f32 v236, v236, v252
    v_add_f32 v237, v237, v253
    v_add_f32 v238, v238, v254
    v_add_f32 v239, v239, v255
    buffer_load_dwordx4 v2, s[4:7], s40 offen offset:1024 lds
    v_add_f32 v192, v192, v224
    v_add_f32 v193, v193, v225
    v_add_f32 v194, v194, v226
    v_add_f32 v195, v195, v227
    v_add_f32 v196, v196, v228
    v_add_f32 v197, v197, v229
    buffer_load_dwordx4 v2, s[4:7], s40 offen offset:2048 lds
    v_add_f32 v198, v198, v230
    v_add_f32 v199, v199, v231
    v_add_f32 v200, v200, v232
    v_add_f32 v201, v201, v233
    v_add_f32 v202, v202, v234
    buffer_load_dwordx4 v2, s[4:7], s40 offen offset:3072 lds
    v_add_f32 v203, v203, v235
    v_add_f32 v204, v204, v236
    v_add_f32 v205, v205, v237
    v_add_f32 v206, v206, v238
    v_add_f32 v207, v207, v239
    v_cvt_pk_bf16_f32 v12, v192, v193
    s_add_u32 m0, s42, 4096
    v_cvt_pk_bf16_f32 v13, v194, v195
    v_cvt_pk_bf16_f32 v14, v196, v197
    v_cvt_pk_bf16_f32 v15, v198, v199
    v_cvt_pk_bf16_f32 v16, v200, v201
    v_cvt_pk_bf16_f32 v17, v202, v203
    s_add_u32 s40, s43, 4096
    v_cvt_pk_bf16_f32 v18, v204, v205
    v_cvt_pk_bf16_f32 v19, v206, v207
    s_lshl_b32 s38, s21, 5
    s_lshl_b32 s39, s22, 1
    s_add_u32 s38, s38, s39
    s_lshl_b32 s38, s38, 10
    buffer_load_dwordx4 v2, s[4:7], s40 offen offset:0 lds
    s_add_u32 s38, s38, 0x610000
    buffer_store_dwordx4 v[12:15], v2, s[4:7], s38 offen sc1
    buffer_store_dwordx4 v[16:19], v2, s[4:7], s38 offen offset:1024 sc1
    v_add_f32 v36, v192, v193
    v_mul_f32 v37, v192, v192
    buffer_load_dwordx4 v2, s[4:7], s40 offen offset:1024 lds
    v_fmac_f32 v37, v193, v193
    v_add_f32 v36, v36, v194
    v_fmac_f32 v37, v194, v194
    v_add_f32 v36, v36, v195
    v_fmac_f32 v37, v195, v195
    v_add_f32 v36, v36, v196
    buffer_load_dwordx4 v2, s[4:7], s40 offen offset:2048 lds
    v_fmac_f32 v37, v196, v196
    v_add_f32 v36, v36, v197
    v_fmac_f32 v37, v197, v197
    v_add_f32 v36, v36, v198
    v_fmac_f32 v37, v198, v198
    buffer_load_dwordx4 v2, s[4:7], s40 offen offset:3072 lds
    v_add_f32 v36, v36, v199
    v_fmac_f32 v37, v199, v199
    v_add_f32 v36, v36, v200
    v_fmac_f32 v37, v200, v200
    v_add_f32 v36, v36, v201
    v_fmac_f32 v37, v201, v201
    v_add_f32 v36, v36, v202
    v_fmac_f32 v37, v202, v202
    v_add_f32 v36, v36, v203
    v_fmac_f32 v37, v203, v203
    v_add_f32 v36, v36, v204
    v_fmac_f32 v37, v204, v204
    v_add_f32 v36, v36, v205
    v_fmac_f32 v37, v205, v205
    v_add_f32 v36, v36, v206
    v_fmac_f32 v37, v206, v206
    v_add_f32 v36, v36, v207
    v_fmac_f32 v37, v207, v207
    v_mov_b32 v38, v36
    s_nop 1
    v_permlane32_swap_b32 v36, v38
    v_add_f32 v36, v36, v38
    v_mov_b32 v38, v37
    s_nop 1
    v_permlane32_swap_b32 v37, v38
    v_add_f32 v37, v37, v38
    s_lshl_b32 s38, s22, 14
    s_lshl_b32 s39, s21, 8
    s_add_u32 s38, s38, s39
    s_add_u32 s38, s38, 0x14a0000
    v_lshlrev_b32 v38, 3, v4
    buffer_store_dwordx2 v[36:37], v38, s[4:7], s38 offen sc1
    s_waitcnt vmcnt(0)
    s_barrier
    s_cmp_lg_u32 s16, 0
    s_cbranch_scc1 L_f_s1_noarr
    v_lshlrev_b32 v36, 7, v1
    v_mov_b32 v37, 1
    s_mov_b64 exec, 0xffff
    buffer_store_dword v37, v36, s[4:7], s62 offen sc1
    s_nop 0
    s_mov_b64 exec, -1
L_f_s1_noarr:
    s_cmp_lg_u32 s16, 0
    s_cselect_b32 s59, 1, 0
    v_and_b32 v36, 15, v1
    v_lshlrev_b32 v36, 2, v36
    s_cmp_lg_u32 s59, 0
    s_cbranch_scc1 L_f_s1_np0
    buffer_load_dword v37, v36, s[4:7], s44 offen sc1
L_f_s1_np0:
    s_mul_i32 s66, s18, 896
    s_mul_i32 s39, s16, 57344
    s_add_u32 s66, s66, s39
    s_add_u32 s66, s66, 0xb90000
    s_add_u32 s39, s66, 0
    buffer_load_dwordx4 v[64:67], v2, s[4:7], s39 offen
    s_add_u32 s39, s66, 14336
    buffer_load_dwordx4 v[68:71], v2, s[4:7], s39 offen
    s_add_u32 s39, s66, 28672
    buffer_load_dwordx4 v[72:75], v2, s[4:7], s39 offen
    s_add_u32 s39, s66, 43008
    buffer_load_dwordx4 v[76:79], v2, s[4:7], s39 offen
    s_add_u32 s43, s33, 65536
    s_add_u32 s42, s34, 65536
    s_add_u32 m0, s42, 0
    s_add_u32 s40, s43, 0
    buffer_load_dwordx4 v2, s[4:7], s40 offen offset:0 lds
    buffer_load_dwordx4 v2, s[4:7], s40 offen offset:1024 lds
    buffer_load_dwordx4 v2, s[4:7], s40 offen offset:2048 lds
    s_cmp_lg_u32 s59, 0
    s_cbranch_scc1 L_f_s1_nq0
    s_waitcnt vmcnt(7)
    v_cmp_eq_u32 vcc, 1, v37
    s_nop 4
    s_cmp_eq_u64 vcc, exec
    s_cselect_b32 s59, 1, 0
L_f_s1_nq0:
    s_cmp_lg_u32 s59, 0
    s_cbranch_scc1 L_f_s1_np1
    buffer_load_dword v37, v36, s[4:7], s44 offen sc1
L_f_s1_np1:
    buffer_load_dwordx4 v2, s[4:7], s40 offen offset:3072 lds
    s_add_u32 m0, s42, 4096
    s_add_u32 s40, s43, 4096
    buffer_load_dwordx4 v2, s[4:7], s40 offen offset:0 lds
    buffer_load_dwordx4 v2, s[4:7], s40 offen offset:1024 lds
    buffer_load_dwordx4 v2, s[4:7], s40 offen offset:2048 lds
    buffer_load_dwordx4 v2, s[4:7], s40 offen offset:3072 lds
    buffer_load_dwordx4 a[0:3], v2, s[4:7], s70 offen offset:0
    buffer_load_dwordx4 a[4:7], v2, s[4:7], s74 offen offset:0
    s_cmp_lg_u32 s59, 0
    s_cbranch_scc1 L_f_s1_nq1
    s_waitcnt vmcnt(7)
    v_cmp_eq_u32 vcc, 1, v37
    s_nop 4
    s_cmp_eq_u64 vcc, exec
    s_cselect_b32 s59, 1, 0
L_f_s1_nq1:
    s_cmp_lg_u32 s59, 0
    s_cbranch_scc1 L_f_s1_np2
    buffer_load_dword v37, v36, s[4:7], s44 offen sc1
L_f_s1_np2:
    buffer_load_dwordx4 a[8:11], v2, s[4:7], s70 offen offset:1024
    buffer_load_dwordx4 a[12:15], v2, s[4:7], s74 offen offset:1024
    s_waitcnt vmcnt(14)
    v_add_f32 v64, v64, v68
    s_waitcnt vmcnt(12)
    v_add_f32 v72, v72, v76
    v_add_f32 v65, v65, v69
    v_add_f32 v73, v73, v77
    v_add_f32 v66, v66, v70
    v_add_f32 v74, v74, v78
    v_add_f32 v67, v67, v71
    v_add_f32 v75, v75, v79
    v_add_f32 v64, v64, v72
    v_add_f32 v65, v65, v73
    v_add_f32 v66, v66, v74
    v_add_f32 v67, v67, v75
    s_lshl_b32 s39, s16, 10
    s_add_u32 s39, s39, 147456
    v_add_u32 v20, s39, v2
    ds_write_b128 v20, v[64:67]
    s_waitcnt lgkmcnt(0)
    buffer_load_dwordx4 a[16:19], v2, s[4:7], s70 offen offset:2048
    buffer_load_dwordx4 a[20:23], v2, s[4:7], s74 offen offset:2048
    buffer_load_dwordx4 a[24:27], v2, s[4:7], s71 offen offset:0
    buffer_load_dwordx4 a[28:31], v2, s[4:7], s75 offen offset:0
    buffer_load_dwordx4 a[32:35], v2, s[4:7], s71 offen offset:1024
    s_cmp_lg_u32 s59, 0
    s_cbranch_scc1 L_f_s1_nq2
    s_waitcnt vmcnt(7)
    v_cmp_eq_u32 vcc, 1, v37
    s_nop 4
    s_cmp_eq_u64 vcc, exec
    s_cselect_b32 s59, 1, 0
L_f_s1_nq2:
    s_cmp_lg_u32 s59, 0
    s_cbranch_scc1 L_f_s1_np3
    buffer_load_dword v37, v36, s[4:7], s44 offen sc1
L_f_s1_np3:
    buffer_load_dwordx4 a[36:39], v2, s[4:7], s75 offen offset:1024
    buffer_load_dwordx4 a[40:43], v2, s[4:7], s71 offen offset:2048
    buffer_load_dwordx4 a[44:47], v2, s[4:7], s75 offen offset:2048
    buffer_load_dwordx4 a[48:51], v2, s[4:7], s72 offen offset:0
    buffer_load_dwordx4 a[52:55], v2, s[4:7], s76 offen offset:0
    buffer_load_dwordx4 a[56:59], v2, s[4:7], s72 offen offset:1024
    buffer_load_dwordx4 a[60:63], v2, s[4:7], s76 offen offset:1024
    s_cmp_lg_u32 s59, 0
    s_cbranch_scc1 L_f_s1_nq3
    s_waitcnt vmcnt(7)
    v_cmp_eq_u32 vcc, 1, v37
    s_nop 4
    s_cmp_eq_u64 vcc, exec
    s_cselect_b32 s59, 1, 0
L_f_s1_nq3:
    s_mov_b32 s60, 0
L_f_s1_spin:
    s_cmp_lg_u32 s59, 0
    s_cbranch_scc1 L_f_s1_done
    buffer_load_dword v37, v36, s[4:7], s44 offen sc1
    s_waitcnt vmcnt(0)
    v_cmp_eq_u32 vcc, 1, v37
    s_nop 4
    s_cmp_eq_u64 vcc, exec
    s_cselect_b32 s59, 1, 0
    s_add_u32 s60, s60, 1
    s_cmp_lt_u32 s60, 0x40000
    s_cbranch_scc1 L_f_s1_spin
L_f_s1_done:
    s_barrier
    v_add_u32 v22, 8192, v2
    v_add_u32 v23, 12288, v2
    v_add_u32 v24, 16384, v2
    v_add_u32 v25, 20480, v2
    v_add_u32 v26, 24576, v2
    v_add_u32 v27, 28672, v2
    s_lshl_b32 s45, s23, 15
    s_add_u32 s45, s45, 0x610000
    buffer_load_dwordx4 v[128:131], v2, s[4:7], s45 offen offset:0 sc1
    buffer_load_dwordx4 v[132:135], v2, s[4:7], s45 offen offset:1024 sc1
    buffer_load_dwordx4 v[136:139], v2, s[4:7], s45 offen offset:2048 sc1
    buffer_load_dwordx4 v[140:143], v2, s[4:7], s45 offen offset:3072 sc1
    buffer_load_dwordx4 v[144:147], v3, s[4:7], s45 offen offset:0 sc1
    buffer_load_dwordx4 v[148:151], v3, s[4:7], s45 offen offset:1024 sc1
    buffer_load_dwordx4 v[152:155], v3, s[4:7], s45 offen offset:2048 sc1
    buffer_load_dwordx4 v[156:159], v3, s[4:7], s45 offen offset:3072 sc1
    buffer_load_dwordx4 v[160:163], v22, s[4:7], s45 offen offset:0 sc1
    buffer_load_dwordx4 v[164:167], v22, s[4:7], s45 offen offset:1024 sc1
    buffer_load_dwordx4 v[168:171], v22, s[4:7], s45 offen offset:2048 sc1
    buffer_load_dwordx4 v[172:175], v22, s[4:7], s45 offen offset:3072 sc1
    buffer_load_dwordx4 v[176:179], v23, s[4:7], s45 offen offset:0 sc1
    buffer_load_dwordx4 v[180:183], v23, s[4:7], s45 offen offset:1024 sc1
    v_lshlrev_b32 v20, 2, v0
    v_add_u32 v21, 147456, v20
    ds_read_b32 v64, v21 offset:0
    ds_read_b32 v65, v21 offset:1024
    ds_read_b32 v66, v21 offset:2048
    ds_read_b32 v67, v21 offset:3072
    v_add_u32 v20, 162816, v20
    s_waitcnt lgkmcnt(2)
    v_add_f32 v64, v64, v65
    s_waitcnt lgkmcnt(0)
    v_add_f32 v66, v66, v67
    v_add_f32 v64, v64, v66
    ds_write_b32 v20, v64
    v_lshlrev_b32 v21, 3, v4
    v_lshlrev_b32 v28, 17, v6
    v_add_u32 v21, v21, v28
    s_lshl_b32 s46, s23, 8
    s_add_u32 s46, s46, 0x14a0000
    s_mul_i32 s48, s23, 112
    s_mul_i32 s47, s18, 7
    s_add_u32 s48, s48, s47
    s_lshl_b32 s48, s48, 10
    s_add_u32 s48, s48, 0xbe0000
    v_add_u32 v8, 0x10000, v2
    v_lshlrev_b32 v10, 4, v6
    v_add_u32 v10, 162816, v10
    s_waitcnt lgkmcnt(0)
    s_barrier
    ds_read_b128 a[224:227], v2 offset:0
    ds_read_b128 a[228:231], v2 offset:1024
    ds_read_b128 a[232:235], v2 offset:2048
    ds_read_b128 a[236:239], v2 offset:3072
    ds_read_b128 a[240:243], v2 offset:4096
    ds_read_b128 a[244:247], v2 offset:5120
    s_waitcnt lgkmcnt(4)
    s_waitcnt vmcnt(13)
    v_mfma_f32_32x32x16_bf16 v[32:47], a[224:227], v[128:131], 0
    ds_read_b128 a[248:251], v2 offset:6144
    buffer_load_dwordx4 v[184:187], v23, s[4:7], s45 offen offset:2048 sc1
    s_waitcnt vmcnt(13)
    v_mfma_f32_32x32x16_bf16 v[32:47], a[228:231], v[132:135], v[32:47]
    ds_read_b128 a[252:255], v2 offset:7168
    buffer_load_dwordx4 v[188:191], v23, s[4:7], s45 offen offset:3072 sc1
    s_waitcnt lgkmcnt(4)
    s_waitcnt vmcnt(13)
    v_mfma_f32_32x32x16_bf16 v[32:47], a[232:235], v[136:139], v[32:47]
    ds_read_b128 a[224:227], v2 offset:8192
    buffer_load_dwordx4 v[192:195], v24, s[4:7], s45 offen offset:0 sc1
    s_waitcnt vmcnt(13)
    v_mfma_f32_32x32x16_bf16 v[32:47], a[236:239], v[140:143], v[32:47]
    ds_read_b128 a[228:231], v2 offset:9216
    buffer_load_dwordx4 v[196:199], v24, s[4:7], s45 offen offset:1024 sc1
    s_waitcnt lgkmcnt(4)
    s_waitcnt vmcnt(13)
    v_mfma_f32_32x32x16_bf16 v[32:47], a[240:243], v[144:147], v[32:47]
    ds_read_b128 a[232:235], v2 offset:10240
    buffer_load_dwordx4 v[200:203], v24, s[4:7], s45 offen offset:2048 sc1
    s_waitcnt vmcnt(13)
    v_mfma_f32_32x32x16_bf16 v[32:47], a[244:247], v[148:151], v[32:47]
    ds_read_b128 a[236:239], v2 offset:11264
    buffer_load_dwordx4 v[204:207], v24, s[4:7], s45 offen offset:3072 sc1
    s_waitcnt lgkmcnt(4)
    s_waitcnt vmcnt(13)
    v_mfma_f32_32x32x16_bf16 v[32:47], a[248:251], v[152:155], v[32:47]
    ds_read_b128 a[240:243], v2 offset:12288
    buffer_load_dwordx4 v[208:211], v25, s[4:7], s45 offen offset:0 sc1
    s_waitcnt vmcnt(13)
    v_mfma_f32_32x32x16_bf16 v[32:47], a[252:255], v[156:159], v[32:47]
    ds_read_b128 a[244:247], v2 offset:13312
    buffer_load_dwordx4 v[212:215], v25, s[4:7], s45 offen offset:1024 sc1
    s_waitcnt lgkmcnt(4)
    s_waitcnt vmcnt(13)
    v_mfma_f32_32x32x16_bf16 v[32:47], a[224:227], v[160:163], v[32:47]
    ds_read_b128 a[248:251], v2 offset:14336
    buffer_load_dwordx4 v[216:219], v25, s[4:7], s45 offen offset:2048 sc1
    s_waitcnt vmcnt(13)
    v_mfma_f32_32x32x16_bf16 v[32:47], a[228:231], v[164:167], v[32:47]
    ds_read_b128 a[252:255], v2 offset:15360
    buffer_load_dwordx4 v[220:223], v25, s[4:7], s45 offen offset:3072 sc1
    s_waitcnt lgkmcnt(4)
    s_waitcnt vmcnt(13)
    v_mfma_f32_32x32x16_bf16 v[32:47], a[232:235], v[168:171], v[32:47]
    ds_read_b128 a[224:227], v2 offset:16384
    buffer_load_dwordx4 v[224:227], v26, s[4:7], s45 offen offset:0 sc1
    s_waitcnt vmcnt(13)
    v_mfma_f32_32x32x16_bf16 v[32:47], a[236:239], v[172:175], v[32:47]
    ds_read_b128 a[228:231], v2 offset:17408
    buffer_load_dwordx4 v[228:231], v26, s[4:7], s45 offen offset:1024 sc1
    s_waitcnt lgkmcnt(4)
    s_waitcnt vmcnt(13)
    v_mfma_f32_32x32x16_bf16 v[32:47], a[240:243], v[176:179], v[32:47]
    ds_read_b128 a[232:235], v2 offset:18432
    buffer_load_dwordx4 v[232:235], v26, s[4:7], s45 offen offset:2048 sc1
    s_waitcnt vmcnt(13)
    v_mfma_f32_32x32x16_bf16 v[32:47], a[244:247], v[180:183], v[32:47]
    ds_read_b128 a[236:239], v2 offset:19456
    buffer_load_dwordx4 v[236:239], v26, s[4:7], s45 offen offset:3072 sc1
    s_waitcnt lgkmcnt(4)
    s_waitcnt vmcnt(13)
    v_mfma_f32_32x32x16_bf16 v[32:47], a[248:251], v[184:187], v[32:47]
    ds_read_b128 a[240:243], v2 offset:20480
    buffer_load_dwordx4 v[240:243], v27, s[4:7], s45 offen offset:0 sc1
    s_waitcnt vmcnt(13)
    v_mfma_f32_32x32x16_bf16 v[32:47], a[252:255], v[188:191], v[32:47]
    ds_read_b128 a[244:247], v2 offset:21504
    buffer_load_dwordx4 v[244:247], v27, s[4:7], s45 offen offset:1024 sc1
    s_waitcnt lgkmcnt(4)
    s_waitcnt vmcnt(13)
    v_mfma_f32_32x32x16_bf16 v[32:47], a[224:227], v[192:195], v[32:47]
    ds_read_b128 a[248:251], v2 offset:22528
    buffer_load_dwordx4 v[248:251], v27, s[4:7], s45 offen offset:2048 sc1
    s_waitcnt vmcnt(13)
    v_mfma_f32_32x32x16_bf16 v[32:47], a[228:231], v[196:199], v[32:47]
    ds_read_b128 a[252:255], v2 offset:23552
    buffer_load_dwordx4 v[252:255], v27, s[4:7], s45 offen offset:3072 sc1
    s_waitcnt lgkmcnt(4)
    s_waitcnt vmcnt(13)
    v_mfma_f32_32x32x16_bf16 v[32:47], a[232:235], v[200:203], v[32:47]
    ds_read_b128 a[224:227], v2 offset:24576
    s_waitcnt vmcnt(12)
    v_mfma_f32_32x32x16_bf16 v[32:47], a[236:239], v[204:207], v[32:47]
    ds_read_b128 a[228:231], v2 offset:25600
    s_waitcnt lgkmcnt(4)
    s_waitcnt vmcnt(11)
    v_mfma_f32_32x32x16_bf16 v[32:47], a[240:243], v[208:211], v[32:47]
    ds_read_b128 a[232:235], v2 offset:26624
    s_add_u32 s47, s46, 0
    buffer_load_dwordx2 v[104:105], v21, s[4:7], s47 offen sc1
    s_add_u32 s47, s46, 16384
    buffer_load_dwordx2 v[106:107], v21, s[4:7], s47 offen sc1
    s_waitcnt vmcnt(12)
    v_mfma_f32_32x32x16_bf16 v[32:47], a[244:247], v[212:215], v[32:47]
    ds_read_b128 a[236:239], v2 offset:27648
    s_add_u32 s47, s46, 32768
    buffer_load_dwordx2 v[108:109], v21, s[4:7], s47 offen sc1
    s_add_u32 s47, s46, 49152
    buffer_load_dwordx2 v[110:111], v21, s[4:7], s47 offen sc1
    s_waitcnt lgkmcnt(4)
    s_waitcnt vmcnt(13)
    v_mfma_f32_32x32x16_bf16 v[32:47], a[248:251], v[216:219], v[32:47]
    ds_read_b128 a[240:243], v2 offset:28672
    s_add_u32 s47, s46, 65536
    buffer_load_dwordx2 v[112:113], v21, s[4:7], s47 offen sc1
    s_add_u32 s47, s46, 81920
    buffer_load_dwordx2 v[114:115], v21, s[4:7], s47 offen sc1
    s_waitcnt vmcnt(14)
    v_mfma_f32_32x32x16_bf16 v[32:47], a[252:255], v[220:223], v[32:47]
    ds_read_b128 a[244:247], v2 offset:29696
    s_add_u32 s47, s46, 98304
    buffer_load_dwordx2 v[116:117], v21, s[4:7], s47 offen sc1
    s_add_u32 s47, s46, 114688
    buffer_load_dwordx2 v[118:119], v21, s[4:7], s47 offen sc1
    s_waitcnt lgkmcnt(4)
    s_waitcnt vmcnt(15)
    v_mfma_f32_32x32x16_bf16 v[32:47], a[224:227], v[224:227], v[32:47]
    ds_read_b128 a[248:251], v2 offset:30720
    s_waitcnt vmcnt(14)
    v_mfma_f32_32x32x16_bf16 v[32:47], a[228:231], v[228:231], v[32:47]
    ds_read_b128 a[252:255], v2 offset:31744
    s_waitcnt lgkmcnt(4)
    s_waitcnt vmcnt(13)
    v_mfma_f32_32x32x16_bf16 v[32:47], a[232:235], v[232:235], v[32:47]
    s_barrier
    ds_read_b128 a[224:227], v2 offset:32768
    s_add_u32 s43, s33, 98304
    s_add_u32 s42, s34, 98304
    s_add_u32 m0, s42, 0
    s_add_u32 s40, s43, 0
    s_waitcnt vmcnt(12)
    v_mfma_f32_32x32x16_bf16 v[32:47], a[236:239], v[236:239], v[32:47]
    ds_read_b128 a[228:231], v2 offset:33792
    buffer_load_dwordx4 v2, s[4:7], s40 offen offset:0 lds
    s_waitcnt lgkmcnt(4)
    s_waitcnt vmcnt(12)
    v_mfma_f32_32x32x16_bf16 v[32:47], a[240:243], v[240:243], v[32:47]
    ds_read_b128 a[232:235], v2 offset:34816
    buffer_load_dwordx4 v2, s[4:7], s40 offen offset:1024 lds
    s_waitcnt vmcnt(12)
    v_mfma_f32_32x32x16_bf16 v[32:47], a[244:247], v[244:247], v[32:47]
    ds_read_b128 a[236:239], v2 offset:35840
    buffer_load_dwordx4 v2, s[4:7], s40 offen offset:2048 lds
    s_waitcnt lgkmcnt(4)
    s_waitcnt vmcnt(12)
    v_mfma_f32_32x32x16_bf16 v[32:47], a[248:251], v[248:251], v[32:47]
    ds_read_b128 a[240:243], v2 offset:36864
    buffer_load_dwordx4 v2, s[4:7], s40 offen offset:3072 lds
    s_waitcnt vmcnt(12)
    v_mfma_f32_32x32x16_bf16 v[32:47], a[252:255], v[252:255], v[32:47]
    ds_read_b128 a[244:247], v2 offset:37888
    s_waitcnt vmcnt(10)
    v_add_f32 v104, v104, v106
    v_add_f32 v105, v105, v107
    s_waitcnt vmcnt(9)
    v_add_f32 v104, v104, v108
    v_add_f32 v105, v105, v109
    s_waitcnt vmcnt(8)
    v_add_f32 v104, v104, v110
    v_add_f32 v105, v105, v111
    s_waitcnt vmcnt(7)
    v_add_f32 v104, v104, v112
    v_add_f32 v105, v105, v113
    s_waitcnt vmcnt(6)
    v_add_f32 v104, v104, v114
    v_add_f32 v105, v105, v115
    s_waitcnt vmcnt(5)
    v_add_f32 v104, v104, v116
    v_add_f32 v105, v105, v117
    s_waitcnt vmcnt(4)
    v_add_f32 v104, v104, v118
    v_add_f32 v105, v105, v119
    v_mov_b32 v106, v104
    s_nop 1
    v_permlane32_swap_b32 v104, v106
    v_add_f32 v104, v104, v106
    v_mov_b32 v106, v105
    s_nop 1
    v_permlane32_swap_b32 v105, v106
    v_add_f32 v105, v105, v106
    v_mul_f32 v120, 0x3b000000, v104
    v_mul_f32 v105, 0x3b000000, v105
    v_fma_f32 v105, -v120, v120, v105
    v_max_f32 v105, 0, v105
    v_add_f32 v105, 0x3727c5ac, v105
    v_rsq_f32 v121, v105
    v_sub_f32 v122, 0, v120
    v_mul_f32 v123, 0xbfb8aa3b, v121
    v_mul_f32 v124, v121, v121
    s_waitcnt lgkmcnt(4)
    v_mfma_f32_32x32x16_bf16 v[48:63], a[224:227], v[128:131], 0
    ds_read_b128 a[248:251], v2 offset:38912
    ds_read_b128 v[64:67], v10 offset:0
    ds_read_b128 v[68:71], v10 offset:32
    ds_read_b128 v[72:75], v10 offset:64
    ds_read_b128 v[76:79], v10 offset:96
    v_mfma_f32_32x32x16_bf16 v[48:63], a[228:231], v[132:135], v[48:63]
    ds_read_b128 a[252:255], v2 offset:39936
    s_waitcnt lgkmcnt(8)
    v_mfma_f32_32x32x16_bf16 v[48:63], a[232:235], v[136:139], v[48:63]
    ds_read_b128 a[224:227], v2 offset:40960
    s_add_u32 m0, s42, 4096
    s_add_u32 s40, s43, 4096
    buffer_load_dwordx4 v2, s[4:7], s40 offen offset:0 lds
    v_mfma_f32_32x32x16_bf16 v[48:63], a[236:239], v[140:143], v[48:63]
    ds_read_b128 a[228:231], v2 offset:41984
    s_waitcnt lgkmcnt(6)
    v_fma_f32 v80, v122, v64, v32
    v_fma_f32 v84, v122, v65, v33
    s_waitcnt lgkmcnt(4)
    v_fma_f32 v81, v122, v72, v40
    v_fma_f32 v85, v122, v73, v41
    v_mul_f32 v82, v123, v80
    v_mul_f32 v86, v123, v84
    v_mfma_f32_32x32x16_bf16 v[48:63], a[240:243], v[144:147], v[48:63]
    ds_read_b128 a[232:235], v2 offset:43008
    buffer_load_dwordx4 v2, s[4:7], s40 offen offset:1024 lds
    v_mfma_f32_32x32x16_bf16 v[48:63], a[244:247], v[148:151], v[48:63]
    ds_read_b128 a[236:239], v2 offset:44032
    v_exp_f32 v82, v82
    v_exp_f32 v86, v86
    v_mul_f32 v80, v80, v81
    v_mul_f32 v84, v84, v85
    v_add_f32 v82, 1.0, v82
    v_add_f32 v86, 1.0, v86
    s_waitcnt lgkmcnt(4)
    v_mfma_f32_32x32x16_bf16 v[48:63], a[248:251], v[152:155], v[48:63]
    ds_read_b128 a[240:243], v2 offset:45056
    buffer_load_dwordx4 v2, s[4:7], s40 offen offset:2048 lds
    v_mfma_f32_32x32x16_bf16 v[48:63], a[252:255], v[156:159], v[48:63]
    ds_read_b128 a[244:247], v2 offset:46080
    v_rcp_f32 v82, v82
    v_rcp_f32 v86, v86
    v_mul_f32 v80, v124, v80
    v_mul_f32 v84, v124, v84
    v_mul_f32 v88, v80, v82
    v_mul_f32 v89, v84, v86
    s_waitcnt lgkmcnt(4)
    v_mfma_f32_32x32x16_bf16 v[48:63], a[224:227], v[160:163], v[48:63]
    ds_read_b128 a[248:251], v2 offset:47104
    buffer_load_dwordx4 v2, s[4:7], s40 offen offset:3072 lds
    v_mfma_f32_32x32x16_bf16 v[48:63], a[228:231], v[164:167], v[48:63]
    ds_read_b128 a[252:255], v2 offset:48128
    v_cvt_pk_bf16_f32 v96, v88, v89
    v_fma_f32 v80, v122, v66, v34
    v_fma_f32 v84, v122, v67, v35
    v_fma_f32 v81, v122, v74, v42
    v_fma_f32 v85, v122, v75, v43
    v_mul_f32 v82, v123, v80
    s_waitcnt lgkmcnt(4)
    v_mfma_f32_32x32x16_bf16 v[48:63], a[232:235], v[168:171], v[48:63]
    ds_read_b128 a[224:227], v2 offset:49152
    buffer_load_dwordx4 a[64:67], v2, s[4:7], s72 offen offset:2048
    v_mfma_f32_32x32x16_bf16 v[48:63], a[236:239], v[172:175], v[48:63]
    ds_read_b128 a[228:231], v2 offset:50176
    v_mul_f32 v86, v123, v84
    v_exp_f32 v82, v82
    v_exp_f32 v86, v86
    v_mul_f32 v80, v80, v81
    v_mul_f32 v84, v84, v85
    v_add_f32 v82, 1.0, v82
    s_waitcnt lgkmcnt(4)
    v_mfma_f32_32x32x16_bf16 v[48:63], a[240:243], v[176:179], v[48:63]
    ds_read_b128 a[232:235], v2 offset:51200
    buffer_load_dwordx4 a[68:71], v2, s[4:7], s76 offen offset:2048
    v_mfma_f32_32x32x16_bf16 v[48:63], a[244:247], v[180:183], v[48:63]
    ds_read_b128 a[236:239], v2 offset:52224
    v_add_f32 v86, 1.0, v86
    v_rcp_f32 v82, v82
    v_rcp_f32 v86, v86
    v_mul_f32 v80, v124, v80
    v_mul_f32 v84, v124, v84
    v_mul_f32 v90, v80, v82
    s_waitcnt lgkmcnt(4)
    v_mfma_f32_32x32x16_bf16 v[48:63], a[248:251], v[184:187], v[48:63]
    ds_read_b128 a[240:243], v2 offset:53248
    v_mul_f32 v91, v84, v86
    v_cvt_pk_bf16_f32 v97, v90, v91
    v_fma_f32 v80, v122, v68, v36
    v_fma_f32 v84, v122, v69, v37
    v_fma_f32 v81, v122, v76, v44
    v_mfma_f32_32x32x16_bf16 v[48:63], a[252:255], v[188:191], v[48:63]
    ds_read_b128 a[244:247], v2 offset:54272
    buffer_load_dwordx4 a[72:75], v2, s[4:7], s73 offen offset:0
    s_waitcnt lgkmcnt(4)
    v_mfma_f32_32x32x16_bf16 v[48:63], a[224:227], v[192:195], v[48:63]
    ds_read_b128 a[248:251], v2 offset:55296
    v_fma_f32 v85, v122, v77, v45
    v_mul_f32 v82, v123, v80
    v_mul_f32 v86, v123, v84
    v_exp_f32 v82, v82
    v_exp_f32 v86, v86
    v_mul_f32 v80, v80, v81
    v_mfma_f32_32x32x16_bf16 v[48:63], a[228:231], v[196:199], v[48:63]
    ds_read_b128 a[252:255], v2 offset:56320
    buffer_load_dwordx4 a[76:79], v2, s[4:7], s77 offen offset:0
    s_waitcnt lgkmcnt(4)
    v_mfma_f32_32x32x16_bf16 v[48:63], a[232:235], v[200:203], v[48:63]
    ds_read_b128 a[224:227], v2 offset:57344
    v_mul_f32 v84, v84, v85
    v_add_f32 v82, 1.0, v82
    v_add_f32 v86, 1.0, v86
    v_rcp_f32 v82, v82
    v_rcp_f32 v86, v86
    v_mul_f32 v80, v124, v80
    v_mfma_f32_32x32x16_bf16 v[48:63], a[236:239], v[204:207], v[48:63]
    ds_read_b128 a[228:231], v2 offset:58368
    buffer_load_dwordx4 a[80:83], v2, s[4:7], s73 offen offset:1024
    s_waitcnt lgkmcnt(4)
    v_mfma_f32_32x32x16_bf16 v[48:63], a[240:243], v[208:211], v[48:63]
    ds_read_b128 a[232:235], v2 offset:59392
    v_mul_f32 v84, v124, v84
    v_mul_f32 v92, v80, v82
    v_mul_f32 v93, v84, v86
    v_cvt_pk_bf16_f32 v98, v92, v93
    v_fma_f32 v80, v122, v70, v38
    v_fma_f32 v84, v122, v71, v39
    v_mfma_f32_32x32x16_bf16 v[48:63], a[244:247], v[212:215], v[48:63]
    ds_read_b128 a[236:239], v2 offset:60416
    buffer_load_dwordx4 a[84:87], v2, s[4:7], s77 offen offset:1024
    s_waitcnt lgkmcnt(4)
    v_mfma_f32_32x32x16_bf16 v[48:63], a[248:251], v[216:219], v[48:63]
    ds_read_b128 a[240:243], v2 offset:61440
    v_fma_f32 v81, v122, v78, v46
    v_fma_f32 v85, v122, v79, v47
    v_mul_f32 v82, v123, v80
    v_mul_f32 v86, v123, v84
    v_exp_f32 v82, v82
    v_exp_f32 v86, v86
    v_mfma_f32_32x32x16_bf16 v[48:63], a[252:255], v[220:223], v[48:63]
    ds_read_b128 a[244:247], v2 offset:62464
    buffer_load_dwordx4 a[88:91], v2, s[4:7], s73 offen offset:2048
    s_waitcnt lgkmcnt(4)
    v_mfma_f32_32x32x16_bf16 v[48:63], a[224:227], v[224:227], v[48:63]
    ds_read_b128 a[248:251], v2 offset:63488
    v_mul_f32 v80, v80, v81
    v_mul_f32 v84, v84, v85
    v_add_f32 v82, 1.0, v82
    v_add_f32 v86, 1.0, v86
    v_rcp_f32 v82, v82
    v_rcp_f32 v86, v86
    v_mfma_f32_32x32x16_bf16 v[48:63], a[228:231], v[228:231], v[48:63]
    ds_read_b128 a[252:255], v2 offset:64512
    buffer_load_dwordx4 a[92:95], v2, s[4:7], s77 offen offset:2048
    s_waitcnt lgkmcnt(4)
    v_mfma_f32_32x32x16_bf16 v[48:63], a[232:235], v[232:235], v[48:63]
    s_barrier
    ds_read_b128 a[224:227], v8 offset:0
    v_mul_f32 v80, v124, v80
    v_mul_f32 v84, v124, v84
    v_mul_f32 v94, v80, v82
    v_mul_f32 v95, v84, v86
    v_cvt_pk_bf16_f32 v99, v94, v95
    s_add_u32 s49, s48, 0
    buffer_store_dwordx4 v[96:99], v2, s[4:7], s49 offen sc1
    s_add_u32 s43, s33, 131072
    s_add_u32 s42, s34, 0
    s_add_u32 m0, s42, 0
    s_add_u32 s40, s43, 0
    v_mfma_f32_32x32x16_bf16 v[48:63], a[236:239], v[236:239], v[48:63]
    ds_read_b128 a[228:231], v8 offset:1024
    buffer_load_dwordx4 v2, s[4:7], s40 offen offset:0 lds
    s_waitcnt lgkmcnt(4)
    v_mfma_f32_32x32x16_bf16 v[48:63], a[240:243], v[240:243], v[48:63]
    ds_read_b128 a[232:235], v8 offset:2048
    buffer_load_dwordx4 v2, s[4:7], s40 offen offset:1024 lds
    v_mfma_f32_32x32x16_bf16 v[48:63], a[244:247], v[244:247], v[48:63]
    ds_read_b128 a[236:239], v8 offset:3072
    buffer_load_dwordx4 v2, s[4:7], s40 offen offset:2048 lds
    s_waitcnt lgkmcnt(4)
    v_mfma_f32_32x32x16_bf16 v[48:63], a[248:251], v[248:251], v[48:63]
    ds_read_b128 a[240:243], v8 offset:4096
    buffer_load_dwordx4 v2, s[4:7], s40 offen offset:3072 lds
    v_mfma_f32_32x32x16_bf16 v[48:63], a[252:255], v[252:255], v[48:63]
    ds_read_b128 a[244:247], v8 offset:5120
    s_waitcnt lgkmcnt(4)
    v_mfma_f32_32x32x16_bf16 v[32:47], a[224:227], v[128:131], 0
    ds_read_b128 a[248:251], v8 offset:6144
    ds_read_b128 v[64:67], v10 offset:128
    ds_read_b128 v[68:71], v10 offset:160
    ds_read_b128 v[72:75], v10 offset:192
    ds_read_b128 v[76:79], v10 offset:224
    v_mfma_f32_32x32x16_bf16 v[32:47], a[228:231], v[132:135], v[32:47]
    ds_read_b128 a[252:255], v8 offset:7168
    s_waitcnt lgkmcnt(8)
    v_mfma_f32_32x32x16_bf16 v[32:47], a[232:235], v[136:139], v[32:47]
    ds_read_b128 a[224:227], v8 offset:8192
    s_add_u32 m0, s42, 4096
    s_add_u32 s40, s43, 4096
    buffer_load_dwordx4 v2, s[4:7], s40 offen offset:0 lds
    v_mfma_f32_32x32x16_bf16 v[32:47], a[236:239], v[140:143], v[32:47]
    ds_read_b128 a[228:231], v8 offset:9216
    s_waitcnt lgkmcnt(6)
    v_fma_f32 v80, v122, v64, v48
    v_fma_f32 v84, v122, v65, v49
    s_waitcnt lgkmcnt(4)
    v_fma_f32 v81, v122, v72, v56
    v_fma_f32 v85, v122, v73, v57
    v_mul_f32 v82, v123, v80
    v_mul_f32 v86, v123, v84
    v_mfma_f32_32x32x16_bf16 v[32:47], a[240:243], v[144:147], v[32:47]
    ds_read_b128 a[232:235], v8 offset:10240
    buffer_load_dwordx4 v2, s[4:7], s40 offen offset:1024 lds
    v_mfma_f32_32x32x16_bf16 v[32:47], a[244:247], v[148:151], v[32:47]
    ds_read_b128 a[236:239], v8 offset:11264
    v_exp_f32 v82, v82
    v_exp_f32 v86, v86
    v_mul_f32 v80, v80, v81
    v_mul_f32 v84, v84, v85
    v_add_f32 v82, 1.0, v82
    v_add_f32 v86, 1.0, v86
    s_waitcnt lgkmcnt(4)
    v_mfma_f32_32x32x16_bf16 v[32:47], a[248:251], v[152:155], v[32:47]
    ds_read_b128 a[240:243], v8 offset:12288
    buffer_load_dwordx4 v2, s[4:7], s40 offen offset:2048 lds
    v_mfma_f32_32x32x16_bf16 v[32:47], a[252:255], v[156:159], v[32:47]
    ds_read_b128 a[244:247], v8 offset:13312
    v_rcp_f32 v82, v82
    v_rcp_f32 v86, v86
    v_mul_f32 v80, v124, v80
    v_mul_f32 v84, v124, v84
    v_mul_f32 v88, v80, v82
    v_mul_f32 v89, v84, v86
    s_waitcnt lgkmcnt(4)
    v_mfma_f32_32x32x16_bf16 v[32:47], a[224:227], v[160:163], v[32:47]
    ds_read_b128 a[248:251], v8 offset:14336
    buffer_load_dwordx4 v2, s[4:7], s40 offen offset:3072 lds
    v_mfma_f32_32x32x16_bf16 v[32:47], a[228:231], v[164:167], v[32:47]
    ds_read_b128 a[252:255], v8 offset:15360
    v_cvt_pk_bf16_f32 v96, v88, v89
    v_fma_f32 v80, v122, v66, v50
    v_fma_f32 v84, v122, v67, v51
    v_fma_f32 v81, v122, v74, v58
    v_fma_f32 v85, v122, v75, v59
    v_mul_f32 v82, v123, v80
    s_waitcnt lgkmcnt(4)
    v_mfma_f32_32x32x16_bf16 v[32:47], a[232:235], v[168:171], v[32:47]
    ds_read_b128 a[224:227], v8 offset:16384
    buffer_load_dwordx4 a[96:99], v2, s[4:7], s70 offen offset:3072
    v_mfma_f32_32x32x16_bf16 v[32:47], a[236:239], v[172:175], v[32:47]
    ds_read_b128 a[228:231], v8 offset:17408
    v_mul_f32 v86, v123, v84
    v_exp_f32 v82, v82
    v_exp_f32 v86, v86
    v_mul_f32 v80, v80, v81
    v_mul_f32 v84, v84, v85
    v_add_f32 v82, 1.0, v82
    s_waitcnt lgkmcnt(4)
    v_mfma_f32_32x32x16_bf16 v[32:47], a[240:243], v[176:179], v[32:47]
    ds_read_b128 a[232:235], v8 offset:18432
    buffer_load_dwordx4 a[100:103], v2, s[4:7], s74 offen offset:3072
    v_mfma_f32_32x32x16_bf16 v[32:47], a[244:247], v[180:183], v[32:47]
    ds_read_b128 a[236:239], v8 offset:19456
    v_add_f32 v86, 1.0, v86
    v_rcp_f32 v82, v82
    v_rcp_f32 v86, v86
    v_mul_f32 v80, v124, v80
    v_mul_f32 v84, v124, v84
    v_mul_f32 v90, v80, v82
    s_waitcnt lgkmcnt(4)
    v_mfma_f32_32x32x16_bf16 v[32:47], a[248:251], v[184:187], v[32:47]
    ds_read_b128 a[240:243], v8 offset:20480
    v_mul_f32 v91, v84, v86
    v_cvt_pk_bf16_f32 v97, v90, v91
    v_fma_f32 v80, v122, v68, v52
    v_fma_f32 v84, v122, v69, v53
    v_fma_f32 v81, v122, v76, v60
    v_mfma_f32_32x32x16_bf16 v[32:47], a[252:255], v[188:191], v[32:47]
    ds_read_b128 a[244:247], v8 offset:21504
    buffer_load_dwordx4 a[104:107], v3, s[4:7], s70 offen offset:0
    s_waitcnt lgkmcnt(4)
    v_mfma_f32_32x32x16_bf16 v[32:47], a[224:227], v[192:195], v[32:47]
    ds_read_b128 a[248:251], v8 offset:22528
    v_fma_f32 v85, v122, v77, v61
    v_mul_f32 v82, v123, v80
    v_mul_f32 v86, v123, v84
    v_exp_f32 v82, v82
    v_exp_f32 v86, v86
    v_mul_f32 v80, v80, v81
    v_mfma_f32_32x32x16_bf16 v[32:47], a[228:231], v[196:199], v[32:47]
    ds_read_b128 a[252:255], v8 offset:23552
    buffer_load_dwordx4 a[108:111], v3, s[4:7], s74 offen offset:0
    s_waitcnt lgkmcnt(4)
    v_mfma_f32_32x32x16_bf16 v[32:47], a[232:235], v[200:203], v[32:47]
    ds_read_b128 a[224:227], v8 offset:24576
    v_mul_f32 v84, v84, v85
    v_add_f32 v82, 1.0, v82
    v_add_f32 v86, 1.0, v86
    v_rcp_f32 v82, v82
    v_rcp_f32 v86, v86
    v_mul_f32 v80, v124, v80
    v_mfma_f32_32x32x16_bf16 v[32:47], a[236:239], v[204:207], v[32:47]
    ds_read_b128 a[228:231], v8 offset:25600
    buffer_load_dwordx4 a[112:115], v2, s[4:7], s71 offen offset:3072
    s_waitcnt lgkmcnt(4)
    v_mfma_f32_32x32x16_bf16 v[32:47], a[240:243], v[208:211], v[32:47]
    ds_read_b128 a[232:235], v8 offset:26624
    v_mul_f32 v84, v124, v84
    v_mul_f32 v92, v80, v82
    v_mul_f32 v93, v84, v86
    v_cvt_pk_bf16_f32 v98, v92, v93
    v_fma_f32 v80, v122, v70, v54
    v_fma_f32 v84, v122, v71, v55
    v_mfma_f32_32x32x16_bf16 v[32:47], a[244:247], v[212:215], v[32:47]
    ds_read_b128 a[236:239], v8 offset:27648
    buffer_load_dwordx4 a[116:119], v2, s[4:7], s75 offen offset:3072
    s_waitcnt lgkmcnt(4)
    v_mfma_f32_32x32x16_bf16 v[32:47], a[248:251], v[216:219], v[32:47]
    ds_read_b128 a[240:243], v8 offset:28672
    v_fma_f32 v81, v122, v78, v62
    v_fma_f32 v85, v122, v79, v63
    v_mul_f32 v82, v123, v80
    v_mul_f32 v86, v123, v84
    v_exp_f32 v82, v82
    v_exp_f32 v86, v86
    v_mfma_f32_32x32x16_bf16 v[32:47], a[252:255], v[220:223], v[32:47]
    ds_read_b128 a[244:247], v8 offset:29696
    buffer_load_dwordx4 a[120:123], v3, s[4:7], s71 offen offset:0
    s_waitcnt lgkmcnt(4)
    v_mfma_f32_32x32x16_bf16 v[32:47], a[224:227], v[224:227], v[32:47]
    ds_read_b128 a[248:251], v8 offset:30720
    v_mul_f32 v80, v80, v81
    v_mul_f32 v84, v84, v85
    v_add_f32 v82, 1.0, v82
    v_add_f32 v86, 1.0, v86
    v_rcp_f32 v82, v82
    v_rcp_f32 v86, v86
    v_mfma_f32_32x32x16_bf16 v[32:47], a[228:231], v[228:231], v[32:47]
    ds_read_b128 a[252:255], v8 offset:31744
    buffer_load_dwordx4 a[124:127], v3, s[4:7], s75 offen offset:0
    s_waitcnt lgkmcnt(4)
    v_mfma_f32_32x32x16_bf16 v[32:47], a[232:235], v[232:235], v[32:47]
    s_waitcnt vmcnt(25)
    s_barrier
    ds_read_b128 a[224:227], v8 offset:32768
    v_mul_f32 v80, v124, v80
    v_mul_f32 v84, v124, v84
    v_mul_f32 v94, v80, v82
    v_mul_f32 v95, v84, v86
    v_cvt_pk_bf16_f32 v99, v94, v95
    s_add_u32 s49, s48, 1024
    buffer_store_dwordx4 v[96:99], v2, s[4:7], s49 offen sc1
    s_add_u32 s43, s33, 163840
    s_add_u32 s42, s34, 32768
    s_add_u32 m0, s42, 0
    s_add_u32 s40, s43, 0
    v_mfma_f32_32x32x16_bf16 v[32:47], a[236:239], v[236:239], v[32:47]
    ds_read_b128 a[228:231], v8 offset:33792
    buffer_load_dwordx4 v2, s[4:7], s40 offen offset:0 lds
    s_waitcnt lgkmcnt(4)
    v_mfma_f32_32x32x16_bf16 v[32:47], a[240:243], v[240:243], v[32:47]
    ds_read_b128 a[232:235], v8 offset:34816
    buffer_load_dwordx4 v2, s[4:7], s40 offen offset:1024 lds
    v_mfma_f32_32x32x16_bf16 v[32:47], a[244:247], v[244:247], v[32:47]
    ds_read_b128 a[236:239], v8 offset:35840
    buffer_load_dwordx4 v2, s[4:7], s40 offen offset:2048 lds
    s_waitcnt lgkmcnt(4)
    v_mfma_f32_32x32x16_bf16 v[32:47], a[248:251], v[248:251], v[32:47]
    ds_read_b128 a[240:243], v8 offset:36864
    buffer_load_dwordx4 v2, s[4:7], s40 offen offset:3072 lds
    v_mfma_f32_32x32x16_bf16 v[32:47], a[252:255], v[252:255], v[32:47]
    ds_read_b128 a[244:247], v8 offset:37888
    s_waitcnt lgkmcnt(4)
    v_mfma_f32_32x32x16_bf16 v[48:63], a[224:227], v[128:131], 0
    ds_read_b128 a[248:251], v8 offset:38912
    ds_read_b128 v[64:67], v10 offset:256
    ds_read_b128 v[68:71], v10 offset:288
    ds_read_b128 v[72:75], v10 offset:320
    ds_read_b128 v[76:79], v10 offset:352
    v_mfma_f32_32x32x16_bf16 v[48:63], a[228:231], v[132:135], v[48:63]
    ds_read_b128 a[252:255], v8 offset:39936
    s_waitcnt lgkmcnt(8)
    v_mfma_f32_32x32x16_bf16 v[48:63], a[232:235], v[136:139], v[48:63]
    ds_read_b128 a[224:227], v8 offset:40960
    s_add_u32 m0, s42, 4096
    s_add_u32 s40, s43, 4096
    buffer_load_dwordx4 v2, s[4:7], s40 offen offset:0 lds
    v_mfma_f32_32x32x16_bf16 v[48:63], a[236:239], v[140:143], v[48:63]
    ds_read_b128 a[228:231], v8 offset:41984
    s_waitcnt lgkmcnt(6)
    v_fma_f32 v80, v122, v64, v32
    v_fma_f32 v84, v122, v65, v33
    s_waitcnt lgkmcnt(4)
    v_fma_f32 v81, v122, v72, v40
    v_fma_f32 v85, v122, v73, v41
    v_mul_f32 v82, v123, v80
    v_mul_f32 v86, v123, v84
    v_mfma_f32_32x32x16_bf16 v[48:63], a[240:243], v[144:147], v[48:63]
    ds_read_b128 a[232:235], v8 offset:43008
    buffer_load_dwordx4 v2, s[4:7], s40 offen offset:1024 lds
    v_mfma_f32_32x32x16_bf16 v[48:63], a[244:247], v[148:151], v[48:63]
    ds_read_b128 a[236:239], v8 offset:44032
    v_exp_f32 v82, v82
    v_exp_f32 v86, v86
    v_mul_f32 v80, v80, v81
    v_mul_f32 v84, v84, v85
    v_add_f32 v82, 1.0, v82
    v_add_f32 v86, 1.0, v86
    s_waitcnt lgkmcnt(4)
    v_mfma_f32_32x32x16_bf16 v[48:63], a[248:251], v[152:155], v[48:63]
    ds_read_b128 a[240:243], v8 offset:45056
    buffer_load_dwordx4 v2, s[4:7], s40 offen offset:2048 lds
    v_mfma_f32_32x32x16_bf16 v[48:63], a[252:255], v[156:159], v[48:63]
    ds_read_b128 a[244:247], v8 offset:46080
    v_rcp_f32 v82, v82
    v_rcp_f32 v86, v86
    v_mul_f32 v80, v124, v80
    v_mul_f32 v84, v124, v84
    v_mul_f32 v88, v80, v82
    v_mul_f32 v89, v84, v86
    s_waitcnt lgkmcnt(4)
    v_mfma_f32_32x32x16_bf16 v[48:63], a[224:227], v[160:163], v[48:63]
    ds_read_b128 a[248:251], v8 offset:47104
    buffer_load_dwordx4 v2, s[4:7], s40 offen offset:3072 lds
    v_mfma_f32_32x32x16_bf16 v[48:63], a[228:231], v[164:167], v[48:63]
    ds_read_b128 a[252:255], v8 offset:48128
    v_cvt_pk_bf16_f32 v96, v88, v89
    v_fma_f32 v80, v122, v66, v34
    v_fma_f32 v84, v122, v67, v35
    v_fma_f32 v81, v122, v74, v42
    v_fma_f32 v85, v122, v75, v43
    v_mul_f32 v82, v123, v80
    s_waitcnt lgkmcnt(4)
    v_mfma_f32_32x32x16_bf16 v[48:63], a[232:235], v[168:171], v[48:63]
    ds_read_b128 a[224:227], v8 offset:49152
    buffer_load_dwordx4 a[128:131], v2, s[4:7], s72 offen offset:3072
    v_mfma_f32_32x32x16_bf16 v[48:63], a[236:239], v[172:175], v[48:63]
    ds_read_b128 a[228:231], v8 offset:50176
    v_mul_f32 v86, v123, v84
    v_exp_f32 v82, v82
    v_exp_f32 v86, v86
    v_mul_f32 v80, v80, v81
    v_mul_f32 v84, v84, v85
    v_add_f32 v82, 1.0, v82
    s_waitcnt lgkmcnt(4)
    v_mfma_f32_32x32x16_bf16 v[48:63], a[240:243], v[176:179], v[48:63]
    ds_read_b128 a[232:235], v8 offset:51200
    buffer_load_dwordx4 a[132:135], v2, s[4:7], s76 offen offset:3072
    v_mfma_f32_32x32x16_bf16 v[48:63], a[244:247], v[180:183], v[48:63]
    ds_read_b128 a[236:239], v8 offset:52224
    v_add_f32 v86, 1.0, v86
    v_rcp_f32 v82, v82
    v_rcp_f32 v86, v86
    v_mul_f32 v80, v124, v80
    v_mul_f32 v84, v124, v84
    v_mul_f32 v90, v80, v82
    s_waitcnt lgkmcnt(4)
    v_mfma_f32_32x32x16_bf16 v[48:63], a[248:251], v[184:187], v[48:63]
    ds_read_b128 a[240:243], v8 offset:53248
    v_mul_f32 v91, v84, v86
    v_cvt_pk_bf16_f32 v97, v90, v91
    v_fma_f32 v80, v122, v68, v36
    v_fma_f32 v84, v122, v69, v37
    v_fma_f32 v81, v122, v76, v44
    v_mfma_f32_32x32x16_bf16 v[48:63], a[252:255], v[188:191], v[48:63]
    ds_read_b128 a[244:247], v8 offset:54272
    buffer_load_dwordx4 a[136:139], v3, s[4:7], s72 offen offset:0
    s_waitcnt lgkmcnt(4)
    v_mfma_f32_32x32x16_bf16 v[48:63], a[224:227], v[192:195], v[48:63]
    ds_read_b128 a[248:251], v8 offset:55296
    v_fma_f32 v85, v122, v77, v45
    v_mul_f32 v82, v123, v80
    v_mul_f32 v86, v123, v84
    v_exp_f32 v82, v82
    v_exp_f32 v86, v86
    v_mul_f32 v80, v80, v81
    v_mfma_f32_32x32x16_bf16 v[48:63], a[228:231], v[196:199], v[48:63]
    ds_read_b128 a[252:255], v8 offset:56320
    buffer_load_dwordx4 a[140:143], v3, s[4:7], s76 offen offset:0
    s_waitcnt lgkmcnt(4)
    v_mfma_f32_32x32x16_bf16 v[48:63], a[232:235], v[200:203], v[48:63]
    ds_read_b128 a[224:227], v8 offset:57344
    v_mul_f32 v84, v84, v85
    v_add_f32 v82, 1.0, v82
    v_add_f32 v86, 1.0, v86
    v_rcp_f32 v82, v82
    v_rcp_f32 v86, v86
    v_mul_f32 v80, v124, v80
    v_mfma_f32_32x32x16_bf16 v[48:63], a[236:239], v[204:207], v[48:63]
    ds_read_b128 a[228:231], v8 offset:58368
    buffer_load_dwordx4 a[144:147], v2, s[4:7], s73 offen offset:3072
    s_waitcnt lgkmcnt(4)
    v_mfma_f32_32x32x16_bf16 v[48:63], a[240:243], v[208:211], v[48:63]
    ds_read_b128 a[232:235], v8 offset:59392
    v_mul_f32 v84, v124, v84
    v_mul_f32 v92, v80, v82
    v_mul_f32 v93, v84, v86
    v_cvt_pk_bf16_f32 v98, v92, v93
    v_fma_f32 v80, v122, v70, v38
    v_fma_f32 v84, v122, v71, v39
    v_mfma_f32_32x32x16_bf16 v[48:63], a[244:247], v[212:215], v[48:63]
    ds_read_b128 a[236:239], v8 offset:60416
    buffer_load_dwordx4 a[148:151], v2, s[4:7], s77 offen offset:3072
    s_waitcnt lgkmcnt(4)
    v_mfma_f32_32x32x16_bf16 v[48:63], a[248:251], v[216:219], v[48:63]
    ds_read_b128 a[240:243], v8 offset:61440
    v_fma_f32 v81, v122, v78, v46
    v_fma_f32 v85, v122, v79, v47
    v_mul_f32 v82, v123, v80
    v_mul_f32 v86, v123, v84
    v_exp_f32 v82, v82
    v_exp_f32 v86, v86
    v_mfma_f32_32x32x16_bf16 v[48:63], a[252:255], v[220:223], v[48:63]
    ds_read_b128 a[244:247], v8 offset:62464
    buffer_load_dwordx4 a[152:155], v3, s[4:7], s73 offen offset:0
    s_waitcnt lgkmcnt(4)
    v_mfma_f32_32x32x16_bf16 v[48:63], a[224:227], v[224:227], v[48:63]
    ds_read_b128 a[248:251], v8 offset:63488
    v_mul_f32 v80, v80, v81
    v_mul_f32 v84, v84, v85
    v_add_f32 v82, 1.0, v82
    v_add_f32 v86, 1.0, v86
    v_rcp_f32 v82, v82
    v_rcp_f32 v86, v86
    v_mfma_f32_32x32x16_bf16 v[48:63], a[228:231], v[228:231], v[48:63]
    ds_read_b128 a[252:255], v8 offset:64512
    buffer_load_dwordx4 a[156:159], v3, s[4:7], s77 offen offset:0
    s_waitcnt lgkmcnt(4)
    v_mfma_f32_32x32x16_bf16 v[48:63], a[232:235], v[232:235], v[48:63]
    s_waitcnt vmcnt(25)
    s_barrier
    ds_read_b128 a[224:227], v2 offset:0
    v_mul_f32 v80, v124, v80
    v_mul_f32 v84, v124, v84
    v_mul_f32 v94, v80, v82
    v_mul_f32 v95, v84, v86
    v_cvt_pk_bf16_f32 v99, v94, v95
    s_add_u32 s49, s48, 2048
    buffer_store_dwordx4 v[96:99], v2, s[4:7], s49 offen sc1
    s_add_u32 s43, s33, 196608
    s_add_u32 s42, s34, 65536
    s_add_u32 m0, s42, 0
    s_add_u32 s40, s43, 0
    v_mfma_f32_32x32x16_bf16 v[48:63], a[236:239], v[236:239], v[48:63]
    ds_read_b128 a[228:231], v2 offset:1024
    buffer_load_dwordx4 v2, s[4:7], s40 offen offset:0 lds
    s_waitcnt lgkmcnt(4)
    v_mfma_f32_32x32x16_bf16 v[48:63], a[240:243], v[240:243], v[48:63]
    ds_read_b128 a[232:235], v2 offset:2048
    buffer_load_dwordx4 v2, s[4:7], s40 offen offset:1024 lds
    v_mfma_f32_32x32x16_bf16 v[48:63], a[244:247], v[244:247], v[48:63]
    ds_read_b128 a[236:239], v2 offset:3072
    buffer_load_dwordx4 v2, s[4:7], s40 offen offset:2048 lds
    s_waitcnt lgkmcnt(4)
    v_mfma_f32_32x32x16_bf16 v[48:63], a[248:251], v[248:251], v[48:63]
    ds_read_b128 a[240:243], v2 offset:4096
    buffer_load_dwordx4 v2, s[4:7], s40 offen offset:3072 lds
    v_mfma_f32_32x32x16_bf16 v[48:63], a[252:255], v[252:255], v[48:63]
    ds_read_b128 a[244:247], v2 offset:5120
    s_waitcnt lgkmcnt(4)
    v_mfma_f32_32x32x16_bf16 v[32:47], a[224:227], v[128:131], 0
    ds_read_b128 a[248:251], v2 offset:6144
    ds_read_b128 v[64:67], v10 offset:384
    ds_read_b128 v[68:71], v10 offset:416
    ds_read_b128 v[72:75], v10 offset:448
    ds_read_b128 v[76:79], v10 offset:480
    v_mfma_f32_32x32x16_bf16 v[32:47], a[228:231], v[132:135], v[32:47]
    ds_read_b128 a[252:255], v2 offset:7168
    s_waitcnt lgkmcnt(8)
    v_mfma_f32_32x32x16_bf16 v[32:47], a[232:235], v[136:139], v[32:47]
    ds_read_b128 a[224:227], v2 offset:8192
    s_add_u32 m0, s42, 4096
    s_add_u32 s40, s43, 4096
    buffer_load_dwordx4 v2, s[4:7], s40 offen offset:0 lds
    v_mfma_f32_32x32x16_bf16 v[32:47], a[236:239], v[140:143], v[32:47]
    ds_read_b128 a[228:231], v2 offset:9216
    s_waitcnt lgkmcnt(6)
    v_fma_f32 v80, v122, v64, v48
    v_fma_f32 v84, v122, v65, v49
    s_waitcnt lgkmcnt(4)
    v_fma_f32 v81, v122, v72, v56
    v_fma_f32 v85, v122, v73, v57
    v_mul_f32 v82, v123, v80
    v_mul_f32 v86, v123, v84
    v_mfma_f32_32x32x16_bf16 v[32:47], a[240:243], v[144:147], v[32:47]
    ds_read_b128 a[232:235], v2 offset:10240
    buffer_load_dwordx4 v2, s[4:7], s40 offen offset:1024 lds
    v_mfma_f32_32x32x16_bf16 v[32:47], a[244:247], v[148:151], v[32:47]
    ds_read_b128 a[236:239], v2 offset:11264
    v_exp_f32 v82, v82
    v_exp_f32 v86, v86
    v_mul_f32 v80, v80, v81
    v_mul_f32 v84, v84, v85
    v_add_f32 v82, 1.0, v82
    v_add_f32 v86, 1.0, v86
    s_waitcnt lgkmcnt(4)
    v_mfma_f32_32x32x16_bf16 v[32:47], a[248:251], v[152:155], v[32:47]
    ds_read_b128 a[240:243], v2 offset:12288
    buffer_load_dwordx4 v2, s[4:7], s40 offen offset:2048 lds
    v_mfma_f32_32x32x16_bf16 v[32:47], a[252:255], v[156:159], v[32:47]
    ds_read_b128 a[244:247], v2 offset:13312
    v_rcp_f32 v82, v82
    v_rcp_f32 v86, v86
    v_mul_f32 v80, v124, v80
    v_mul_f32 v84, v124, v84
    v_mul_f32 v88, v80, v82
    v_mul_f32 v89, v84, v86
    s_waitcnt lgkmcnt(4)
    v_mfma_f32_32x32x16_bf16 v[32:47], a[224:227], v[160:163], v[32:47]
    ds_read_b128 a[248:251], v2 offset:14336
    buffer_load_dwordx4 v2, s[4:7], s40 offen offset:3072 lds
    v_mfma_f32_32x32x16_bf16 v[32:47], a[228:231], v[164:167], v[32:47]
    ds_read_b128 a[252:255], v2 offset:15360
    v_cvt_pk_bf16_f32 v96, v88, v89
    v_fma_f32 v80, v122, v66, v50
    v_fma_f32 v84, v122, v67, v51
    v_fma_f32 v81, v122, v74, v58
    v_fma_f32 v85, v122, v75, v59
    v_mul_f32 v82, v123, v80
    s_waitcnt lgkmcnt(4)
    v_mfma_f32_32x32x16_bf16 v[32:47], a[232:235], v[168:171], v[32:47]
    ds_read_b128 a[224:227], v2 offset:16384
    buffer_load_dwordx4 a[160:163], v3, s[4:7], s70 offen offset:1024
    v_mfma_f32_32x32x16_bf16 v[32:47], a[236:239], v[172:175], v[32:47]
    ds_read_b128 a[228:231], v2 offset:17408
    v_mul_f32 v86, v123, v84
    v_exp_f32 v82, v82
    v_exp_f32 v86, v86
    v_mul_f32 v80, v80, v81
    v_mul_f32 v84, v84, v85
    v_add_f32 v82, 1.0, v82
    s_waitcnt lgkmcnt(4)
    v_mfma_f32_32x32x16_bf16 v[32:47], a[240:243], v[176:179], v[32:47]
    ds_read_b128 a[232:235], v2 offset:18432
    buffer_load_dwordx4 a[164:167], v3, s[4:7], s74 offen offset:1024
    v_mfma_f32_32x32x16_bf16 v[32:47], a[244:247], v[180:183], v[32:47]
    ds_read_b128 a[236:239], v2 offset:19456
    v_add_f32 v86, 1.0, v86
    v_rcp_f32 v82, v82
    v_rcp_f32 v86, v86
    v_mul_f32 v80, v124, v80
    v_mul_f32 v84, v124, v84
    v_mul_f32 v90, v80, v82
    s_waitcnt lgkmcnt(4)
    v_mfma_f32_32x32x16_bf16 v[32:47], a[248:251], v[184:187], v[32:47]
    ds_read_b128 a[240:243], v2 offset:20480
    v_mul_f32 v91, v84, v86
    v_cvt_pk_bf16_f32 v97, v90, v91
    v_fma_f32 v80, v122, v68, v52
    v_fma_f32 v84, v122, v69, v53
    v_fma_f32 v81, v122, v76, v60
    v_mfma_f32_32x32x16_bf16 v[32:47], a[252:255], v[188:191], v[32:47]
    ds_read_b128 a[244:247], v2 offset:21504
    buffer_load_dwordx4 a[168:171], v3, s[4:7], s70 offen offset:2048
    s_waitcnt lgkmcnt(4)
    v_mfma_f32_32x32x16_bf16 v[32:47], a[224:227], v[192:195], v[32:47]
    ds_read_b128 a[248:251], v2 offset:22528
    v_fma_f32 v85, v122, v77, v61
    v_mul_f32 v82, v123, v80
    v_mul_f32 v86, v123, v84
    v_exp_f32 v82, v82
    v_exp_f32 v86, v86
    v_mul_f32 v80, v80, v81
    v_mfma_f32_32x32x16_bf16 v[32:47], a[228:231], v[196:199], v[32:47]
    ds_read_b128 a[252:255], v2 offset:23552
    buffer_load_dwordx4 a[172:175], v3, s[4:7], s74 offen offset:2048
    s_waitcnt lgkmcnt(4)
    v_mfma_f32_32x32x16_bf16 v[32:47], a[232:235], v[200:203], v[32:47]
    ds_read_b128 a[224:227], v2 offset:24576
    v_mul_f32 v84, v84, v85
    v_add_f32 v82, 1.0, v82
    v_add_f32 v86, 1.0, v86
    v_rcp_f32 v82, v82
    v_rcp_f32 v86, v86
    v_mul_f32 v80, v124, v80
    v_mfma_f32_32x32x16_bf16 v[32:47], a[236:239], v[204:207], v[32:47]
    ds_read_b128 a[228:231], v2 offset:25600
    buffer_load_dwordx4 a[176:179], v3, s[4:7], s71 offen offset:1024
    s_waitcnt lgkmcnt(4)
    v_mfma_f32_32x32x16_bf16 v[32:47], a[240:243], v[208:211], v[32:47]
    ds_read_b128 a[232:235], v2 offset:26624
    v_mul_f32 v84, v124, v84
    v_mul_f32 v92, v80, v82
    v_mul_f32 v93, v84, v86
    v_cvt_pk_bf16_f32 v98, v92, v93
    v_fma_f32 v80, v122, v70, v54
    v_fma_f32 v84, v122, v71, v55
    v_mfma_f32_32x32x16_bf16 v[32:47], a[244:247], v[212:215], v[32:47]
    ds_read_b128 a[236:239], v2 offset:27648
    buffer_load_dwordx4 a[180:183], v3, s[4:7], s75 offen offset:1024
    s_waitcnt lgkmcnt(4)
    v_mfma_f32_32x32x16_bf16 v[32:47], a[248:251], v[216:219], v[32:47]
    ds_read_b128 a[240:243], v2 offset:28672
    v_fma_f32 v81, v122, v78, v62
    v_fma_f32 v85, v122, v79, v63
    v_mul_f32 v82, v123, v80
    v_mul_f32 v86, v123, v84
    v_exp_f32 v82, v82
    v_exp_f32 v86, v86
    v_mfma_f32_32x32x16_bf16 v[32:47], a[252:255], v[220:223], v[32:47]
    ds_read_b128 a[244:247], v2 offset:29696
    buffer_load_dwordx4 a[184:187], v3, s[4:7], s71 offen offset:2048
    s_waitcnt lgkmcnt(4)
    v_mfma_f32_32x32x16_bf16 v[32:47], a[224:227], v[224:227], v[32:47]
    ds_read_b128 a[248:251], v2 offset:30720
    v_mul_f32 v80, v80, v81
    v_mul_f32 v84, v84, v85
    v_add_f32 v82, 1.0, v82
    v_add_f32 v86, 1.0, v86
    v_rcp_f32 v82, v82
    v_rcp_f32 v86, v86
    v_mfma_f32_32x32x16_bf16 v[32:47], a[228:231], v[228:231], v[32:47]
    ds_read_b128 a[252:255], v2 offset:31744
    buffer_load_dwordx4 a[188:191], v3, s[4:7], s75 offen offset:2048
    s_waitcnt lgkmcnt(4)
    v_mfma_f32_32x32x16_bf16 v[32:47], a[232:235], v[232:235], v[32:47]
    s_waitcnt vmcnt(25)
    s_waitcnt vmcnt(16)
    s_barrier
    s_cmp_lg_u32 s16, 0
    s_cbranch_scc1 L_f_fa_nf
    v_lshlrev_b32 v28, 7, v1
    v_mov_b32 v29, 1
    s_mov_b64 exec, 0xffff
    buffer_store_dword v29, v28, s[4:7], s63 offen sc1
    s_nop 0
    s_mov_b64 exec, -1
L_f_fa_nf:
    ds_read_b128 a[224:227], v2 offset:32768
    v_mul_f32 v80, v124, v80
    v_mul_f32 v84, v124, v84
    v_mul_f32 v94, v80, v82
    v_mul_f32 v95, v84, v86
    v_cvt_pk_bf16_f32 v99, v94, v95
    s_add_u32 s49, s48, 3072
    buffer_store_dwordx4 v[96:99], v2, s[4:7], s49 offen sc1
    v_mfma_f32_32x32x16_bf16 v[32:47], a[236:239], v[236:239], v[32:47]
    ds_read_b128 a[228:231], v2 offset:33792
    s_waitcnt lgkmcnt(4)
    v_mfma_f32_32x32x16_bf16 v[32:47], a[240:243], v[240:243], v[32:47]
    ds_read_b128 a[232:235], v2 offset:34816
    v_mfma_f32_32x32x16_bf16 v[32:47], a[244:247], v[244:247], v[32:47]
    ds_read_b128 a[236:239], v2 offset:35840
    s_waitcnt lgkmcnt(4)
    v_mfma_f32_32x32x16_bf16 v[32:47], a[248:251], v[248:251], v[32:47]
    ds_read_b128 a[240:243], v2 offset:36864
    v_mfma_f32_32x32x16_bf16 v[32:47], a[252:255], v[252:255], v[32:47]
    ds_read_b128 a[244:247], v2 offset:37888
    s_waitcnt lgkmcnt(4)
    v_mfma_f32_32x32x16_bf16 v[48:63], a[224:227], v[128:131], 0
    ds_read_b128 a[248:251], v2 offset:38912
    ds_read_b128 v[64:67], v10 offset:512
    ds_read_b128 v[68:71], v10 offset:544
    ds_read_b128 v[72:75], v10 offset:576
    ds_read_b128 v[76:79], v10 offset:608
    v_mfma_f32_32x32x16_bf16 v[48:63], a[228:231], v[132:135], v[48:63]
    ds_read_b128 a[252:255], v2 offset:39936
    s_waitcnt lgkmcnt(8)
    v_mfma_f32_32x32x16_bf16 v[48:63], a[232:235], v[136:139], v[48:63]
    ds_read_b128 a[224:227], v2 offset:40960
    buffer_load_dwordx4 a[192:195], v3, s[4:7], s72 offen offset:1024
    v_mfma_f32_32x32x16_bf16 v[48:63], a[236:239], v[140:143], v[48:63]
    ds_read_b128 a[228:231], v2 offset:41984
    s_waitcnt lgkmcnt(6)
    v_fma_f32 v80, v122, v64, v32
    v_fma_f32 v84, v122, v65, v33
    s_waitcnt lgkmcnt(4)
    v_fma_f32 v81, v122, v72, v40
    v_fma_f32 v85, v122, v73, v41
    v_mul_f32 v82, v123, v80
    v_mfma_f32_32x32x16_bf16 v[48:63], a[240:243], v[144:147], v[48:63]
    ds_read_b128 a[232:235], v2 offset:43008
    buffer_load_dwordx4 a[196:199], v3, s[4:7], s76 offen offset:1024
    v_mfma_f32_32x32x16_bf16 v[48:63], a[244:247], v[148:151], v[48:63]
    ds_read_b128 a[236:239], v2 offset:44032
    v_mul_f32 v86, v123, v84
    v_exp_f32 v82, v82
    v_exp_f32 v86, v86
    v_mul_f32 v80, v80, v81
    s_waitcnt lgkmcnt(4)
    v_mfma_f32_32x32x16_bf16 v[48:63], a[248:251], v[152:155], v[48:63]
    ds_read_b128 a[240:243], v2 offset:45056
    buffer_load_dwordx4 a[200:203], v3, s[4:7], s72 offen offset:2048
    v_mfma_f32_32x32x16_bf16 v[48:63], a[252:255], v[156:159], v[48:63]
    ds_read_b128 a[244:247], v2 offset:46080
    v_mul_f32 v84, v84, v85
    v_add_f32 v82, 1.0, v82
    v_add_f32 v86, 1.0, v86
    v_rcp_f32 v82, v82
    v_rcp_f32 v86, v86
    s_waitcnt lgkmcnt(4)
    v_mfma_f32_32x32x16_bf16 v[48:63], a[224:227], v[160:163], v[48:63]
    ds_read_b128 a[248:251], v2 offset:47104
    buffer_load_dwordx4 a[204:207], v3, s[4:7], s76 offen offset:2048
    v_mfma_f32_32x32x16_bf16 v[48:63], a[228:231], v[164:167], v[48:63]
    ds_read_b128 a[252:255], v2 offset:48128
    v_mul_f32 v80, v124, v80
    v_mul_f32 v84, v124, v84
    v_mul_f32 v88, v80, v82
    v_mul_f32 v89, v84, v86
    s_waitcnt lgkmcnt(4)
    v_mfma_f32_32x32x16_bf16 v[48:63], a[232:235], v[168:171], v[48:63]
    ds_read_b128 a[224:227], v2 offset:49152
    buffer_load_dwordx4 a[208:211], v3, s[4:7], s73 offen offset:1024
    v_mfma_f32_32x32x16_bf16 v[48:63], a[236:239], v[172:175], v[48:63]
    ds_read_b128 a[228:231], v2 offset:50176
    v_cvt_pk_bf16_f32 v96, v88, v89
    v_fma_f32 v80, v122, v66, v34
    v_fma_f32 v84, v122, v67, v35
    v_fma_f32 v81, v122, v74, v42
    v_fma_f32 v85, v122, v75, v43
    s_waitcnt lgkmcnt(4)
    v_mfma_f32_32x32x16_bf16 v[48:63], a[240:243], v[176:179], v[48:63]
    ds_read_b128 a[232:235], v2 offset:51200
    buffer_load_dwordx4 a[212:215], v3, s[4:7], s77 offen offset:1024
    v_mfma_f32_32x32x16_bf16 v[48:63], a[244:247], v[180:183], v[48:63]
    ds_read_b128 a[236:239], v2 offset:52224
    v_mul_f32 v82, v123, v80
    v_mul_f32 v86, v123, v84
    v_exp_f32 v82, v82
    v_exp_f32 v86, v86
    s_waitcnt lgkmcnt(4)
    v_mfma_f32_32x32x16_bf16 v[48:63], a[248:251], v[184:187], v[48:63]
    ds_read_b128 a[240:243], v2 offset:53248
    buffer_load_dwordx4 a[216:219], v3, s[4:7], s73 offen offset:2048
    v_mfma_f32_32x32x16_bf16 v[48:63], a[252:255], v[188:191], v[48:63]
    ds_read_b128 a[244:247], v2 offset:54272
    v_mul_f32 v80, v80, v81
    v_mul_f32 v84, v84, v85
    v_add_f32 v82, 1.0, v82
    v_add_f32 v86, 1.0, v86
    v_rcp_f32 v82, v82
    s_waitcnt lgkmcnt(4)
    v_mfma_f32_32x32x16_bf16 v[48:63], a[224:227], v[192:195], v[48:63]
    ds_read_b128 a[248:251], v2 offset:55296
    buffer_load_dwordx4 a[220:223], v3, s[4:7], s77 offen offset:2048
    v_mfma_f32_32x32x16_bf16 v[48:63], a[228:231], v[196:199], v[48:63]
    ds_read_b128 a[252:255], v2 offset:56320
    v_rcp_f32 v86, v86
    v_mul_f32 v80, v124, v80
    v_mul_f32 v84, v124, v84
    v_mul_f32 v90, v80, v82
    s_waitcnt lgkmcnt(4)
    v_mfma_f32_32x32x16_bf16 v[48:63], a[232:235], v[200:203], v[48:63]
    ds_read_b128 a[224:227], v2 offset:57344
    v_mul_f32 v91, v84, v86
    v_cvt_pk_bf16_f32 v97, v90, v91
    v_fma_f32 v80, v122, v68, v36
    v_fma_f32 v84, v122, v69, v37
    v_fma_f32 v81, v122, v76, v44
    v_mfma_f32_32x32x16_bf16 v[48:63], a[236:239], v[204:207], v[48:63]
    ds_read_b128 a[228:231], v2 offset:58368
    v_fma_f32 v85, v122, v77, v45
    v_mul_f32 v82, v123, v80
    v_mul_f32 v86, v123, v84
    v_exp_f32 v82, v82
    s_waitcnt lgkmcnt(4)
    v_mfma_f32_32x32x16_bf16 v[48:63], a[240:243], v[208:211], v[48:63]
    ds_read_b128 a[232:235], v2 offset:59392
    v_exp_f32 v86, v86
    v_mul_f32 v80, v80, v81
    v_mul_f32 v84, v84, v85
    v_add_f32 v82, 1.0, v82
    v_add_f32 v86, 1.0, v86
    v_mfma_f32_32x32x16_bf16 v[48:63], a[244:247], v[212:215], v[48:63]
    ds_read_b128 a[236:239], v2 offset:60416
    v_rcp_f32 v82, v82
    v_rcp_f32 v86, v86
    v_mul_f32 v80, v124, v80
    v_mul_f32 v84, v124, v84
    s_waitcnt lgkmcnt(4)
    v_mfma_f32_32x32x16_bf16 v[48:63], a[248:251], v[216:219], v[48:63]
    ds_read_b128 a[240:243], v2 offset:61440
    v_mul_f32 v92, v80, v82
    v_mul_f32 v93, v84, v86
    v_cvt_pk_bf16_f32 v98, v92, v93
    v_fma_f32 v80, v122, v70, v38
    v_fma_f32 v84, v122, v71, v39
    v_mfma_f32_32x32x16_bf16 v[48:63], a[252:255], v[220:223], v[48:63]
    ds_read_b128 a[244:247], v2 offset:62464
    v_fma_f32 v81, v122, v78, v46
    v_fma_f32 v85, v122, v79, v47
    v_mul_f32 v82, v123, v80
    v_mul_f32 v86, v123, v84
    s_waitcnt lgkmcnt(4)
    v_mfma_f32_32x32x16_bf16 v[48:63], a[224:227], v[224:227], v[48:63]
    ds_read_b128 a[248:251], v2 offset:63488
    v_exp_f32 v82, v82
    v_exp_f32 v86, v86
    v_mul_f32 v80, v80, v81
    v_mul_f32 v84, v84, v85
    v_add_f32 v82, 1.0, v82
    v_mfma_f32_32x32x16_bf16 v[48:63], a[228:231], v[228:231], v[48:63]
    ds_read_b128 a[252:255], v2 offset:64512
    v_add_f32 v86, 1.0, v86
    v_rcp_f32 v82, v82
    v_rcp_f32 v86, v86
    v_mul_f32 v80, v124, v80
    s_waitcnt lgkmcnt(4)
    v_mfma_f32_32x32x16_bf16 v[48:63], a[232:235], v[232:235], v[48:63]
    s_waitcnt vmcnt(17)
    s_barrier
    ds_read_b128 a[224:227], v8 offset:0
    v_mul_f32 v84, v124, v84
    v_mul_f32 v94, v80, v82
    v_mul_f32 v95, v84, v86
    v_cvt_pk_bf16_f32 v99, v94, v95
    s_add_u32 s49, s48, 4096
    buffer_store_dwordx4 v[96:99], v2, s[4:7], s49 offen sc1
    v_mfma_f32_32x32x16_bf16 v[48:63], a[236:239], v[236:239], v[48:63]
    ds_read_b128 a[228:231], v8 offset:1024
    s_waitcnt lgkmcnt(4)
    v_mfma_f32_32x32x16_bf16 v[48:63], a[240:243], v[240:243], v[48:63]
    ds_read_b128 a[232:235], v8 offset:2048
    v_mfma_f32_32x32x16_bf16 v[48:63], a[244:247], v[244:247], v[48:63]
    ds_read_b128 a[236:239], v8 offset:3072
    s_waitcnt lgkmcnt(4)
    v_mfma_f32_32x32x16_bf16 v[48:63], a[248:251], v[248:251], v[48:63]
    ds_read_b128 a[240:243], v8 offset:4096
    v_mfma_f32_32x32x16_bf16 v[48:63], a[252:255], v[252:255], v[48:63]
    ds_read_b128 a[244:247], v8 offset:5120
    s_waitcnt lgkmcnt(4)
    v_mfma_f32_32x32x16_bf16 v[32:47], a[224:227], v[128:131], 0
    ds_read_b128 a[248:251], v8 offset:6144
    ds_read_b128 v[64:67], v10 offset:640
    ds_read_b128 v[68:71], v10 offset:672
    ds_read_b128 v[72:75], v10 offset:704
    ds_read_b128 v[76:79], v10 offset:736
    v_mfma_f32_32x32x16_bf16 v[32:47], a[228:231], v[132:135], v[32:47]
    ds_read_b128 a[252:255], v8 offset:7168
    s_waitcnt lgkmcnt(8)
    v_mfma_f32_32x32x16_bf16 v[32:47], a[232:235], v[136:139], v[32:47]
    ds_read_b128 a[224:227], v8 offset:8192
    v_mfma_f32_32x32x16_bf16 v[32:47], a[236:239], v[140:143], v[32:47]
    ds_read_b128 a[228:231], v8 offset:9216
    s_waitcnt lgkmcnt(6)
    v_fma_f32 v80, v122, v64, v48
    v_fma_f32 v84, v122, v65, v49
    s_waitcnt lgkmcnt(4)
    v_fma_f32 v81, v122, v72, v56
    v_fma_f32 v85, v122, v73, v57
    v_mfma_f32_32x32x16_bf16 v[32:47], a[240:243], v[144:147], v[32:47]
    ds_read_b128 a[232:235], v8 offset:10240
    v_mul_f32 v82, v123, v80
    v_mul_f32 v86, v123, v84
    v_exp_f32 v82, v82
    v_mfma_f32_32x32x16_bf16 v[32:47], a[244:247], v[148:151], v[32:47]
    ds_read_b128 a[236:239], v8 offset:11264
    v_exp_f32 v86, v86
    v_mul_f32 v80, v80, v81
    v_mul_f32 v84, v84, v85
    s_waitcnt lgkmcnt(4)
    v_mfma_f32_32x32x16_bf16 v[32:47], a[248:251], v[152:155], v[32:47]
    ds_read_b128 a[240:243], v8 offset:12288
    v_add_f32 v82, 1.0, v82
    v_add_f32 v86, 1.0, v86
    v_rcp_f32 v82, v82
    v_mfma_f32_32x32x16_bf16 v[32:47], a[252:255], v[156:159], v[32:47]
    ds_read_b128 a[244:247], v8 offset:13312
    v_rcp_f32 v86, v86
    v_mul_f32 v80, v124, v80
    v_mul_f32 v84, v124, v84
    s_waitcnt lgkmcnt(4)
    v_mfma_f32_32x32x16_bf16 v[32:47], a[224:227], v[160:163], v[32:47]
    ds_read_b128 a[248:251], v8 offset:14336
    v_mul_f32 v88, v80, v82
    v_mul_f32 v89, v84, v86
    v_cvt_pk_bf16_f32 v96, v88, v89
    v_mfma_f32_32x32x16_bf16 v[32:47], a[228:231], v[164:167], v[32:47]
    ds_read_b128 a[252:255], v8 offset:15360
    v_fma_f32 v80, v122, v66, v50
    v_fma_f32 v84, v122, v67, v51
    v_fma_f32 v81, v122, v74, v58
    v_fma_f32 v85, v122, v75, v59
    s_waitcnt lgkmcnt(4)
    v_mfma_f32_32x32x16_bf16 v[32:47], a[232:235], v[168:171], v[32:47]
    s_waitcnt vmcnt(0)
    s_barrier
    s_add_u32 s63, s63, 32768
    s_cmp_lg_u32 s16, 0
    s_cbranch_scc1 L_f_fb_nf
    v_lshlrev_b32 v28, 7, v1
    v_mov_b32 v29, 1
    s_mov_b64 exec, 0xffff
    buffer_store_dword v29, v28, s[4:7], s63 offen sc1
    s_nop 0
    s_mov_b64 exec, -1
L_f_fb_nf:
    ds_read_b128 a[224:227], v8 offset:16384
    v_mul_f32 v82, v123, v80
    v_mul_f32 v86, v123, v84
    v_exp_f32 v82, v82
    v_mfma_f32_32x32x16_bf16 v[32:47], a[236:239], v[172:175], v[32:47]
    ds_read_b128 a[228:231], v8 offset:17408
    v_exp_f32 v86, v86
    v_mul_f32 v80, v80, v81
    v_mul_f32 v84, v84, v85
    s_waitcnt lgkmcnt(4)
    v_mfma_f32_32x32x16_bf16 v[32:47], a[240:243], v[176:179], v[32:47]
    ds_read_b128 a[232:235], v8 offset:18432
    v_add_f32 v82, 1.0, v82
    v_add_f32 v86, 1.0, v86
    v_rcp_f32 v82, v82
    v_mfma_f32_32x32x16_bf16 v[32:47], a[244:247], v[180:183], v[32:47]
    ds_read_b128 a[236:239], v8 offset:19456
    v_rcp_f32 v86, v86
    v_mul_f32 v80, v124, v80
    v_mul_f32 v84, v124, v84
    s_waitcnt lgkmcnt(4)
    v_mfma_f32_32x32x16_bf16 v[32:47], a[248:251], v[184:187], v[32:47]
    ds_read_b128 a[240:243], v8 offset:20480
    v_mul_f32 v90, v80, v82
    v_mul_f32 v91, v84, v86
    v_cvt_pk_bf16_f32 v97, v90, v91
    s_cmp_lg_u32 s16, 0
    s_cbranch_scc1 L_f_pi1
    v_and_b32 v28, 15, v1
    v_lshlrev_b32 v28, 2, v28
    buffer_load_dword v29, v28, s[4:7], s57 offen sc1
L_f_pi1:
    v_mfma_f32_32x32x16_bf16 v[32:47], a[252:255], v[188:191], v[32:47]
    ds_read_b128 a[244:247], v8 offset:21504
    v_fma_f32 v80, v122, v68, v52
    v_fma_f32 v84, v122, v69, v53
    v_fma_f32 v81, v122, v76, v60
    v_fma_f32 v85, v122, v77, v61
    s_waitcnt lgkmcnt(4)
    v_mfma_f32_32x32x16_bf16 v[32:47], a[224:227], v[192:195], v[32:47]
    ds_read_b128 a[248:251], v8 offset:22528
    v_mul_f32 v82, v123, v80
    v_mul_f32 v86, v123, v84
    v_exp_f32 v82, v82
    v_mfma_f32_32x32x16_bf16 v[32:47], a[228:231], v[196:199], v[32:47]
    ds_read_b128 a[252:255], v8 offset:23552
    v_exp_f32 v86, v86
    v_mul_f32 v80, v80, v81
    v_mul_f32 v84, v84, v85
    s_waitcnt lgkmcnt(4)
    v_mfma_f32_32x32x16_bf16 v[32:47], a[232:235], v[200:203], v[32:47]
    ds_read_b128 a[224:227], v8 offset:24576
    v_add_f32 v82, 1.0, v82
    v_add_f32 v86, 1.0, v86
    v_rcp_f32 v82, v82
    v_mfma_f32_32x32x16_bf16 v[32:47], a[236:239], v[204:207], v[32:47]
    ds_read_b128 a[228:231], v8 offset:25600
    v_rcp_f32 v86, v86
    v_mul_f32 v80, v124, v80
    v_mul_f32 v84, v124, v84
    s_waitcnt lgkmcnt(4)
    v_mfma_f32_32x32x16_bf16 v[32:47], a[240:243], v[208:211], v[32:47]
    ds_read_b128 a[232:235], v8 offset:26624
    v_mul_f32 v92, v80, v82
    v_mul_f32 v93, v84, v86
    v_cvt_pk_bf16_f32 v98, v92, v93
    v_mfma_f32_32x32x16_bf16 v[32:47], a[244:247], v[212:215], v[32:47]
    ds_read_b128 a[236:239], v8 offset:27648
    v_fma_f32 v80, v122, v70, v54
    v_fma_f32 v84, v122, v71, v55
    v_fma_f32 v81, v122, v78, v62
    v_fma_f32 v85, v122, v79, v63
    s_waitcnt lgkmcnt(4)
    v_mfma_f32_32x32x16_bf16 v[32:47], a[248:251], v[216:219], v[32:47]
    ds_read_b128 a[240:243], v8 offset:28672
    v_mul_f32 v82, v123, v80
    v_mul_f32 v86, v123, v84
    v_exp_f32 v82, v82
    v_mfma_f32_32x32x16_bf16 v[32:47], a[252:255], v[220:223], v[32:47]
    ds_read_b128 a[244:247], v8 offset:29696
    v_exp_f32 v86, v86
    v_mul_f32 v80, v80, v81
    v_mul_f32 v84, v84, v85
    s_waitcnt lgkmcnt(4)
    v_mfma_f32_32x32x16_bf16 v[32:47], a[224:227], v[224:227], v[32:47]
    ds_read_b128 a[248:251], v8 offset:30720
    v_add_f32 v82, 1.0, v82
    v_add_f32 v86, 1.0, v86
    v_rcp_f32 v82, v82
    v_mfma_f32_32x32x16_bf16 v[32:47], a[228:231], v[228:231], v[32:47]
    ds_read_b128 a[252:255], v8 offset:31744
    v_rcp_f32 v86, v86
    v_mul_f32 v80, v124, v80
    v_mul_f32 v84, v124, v84
    s_waitcnt lgkmcnt(4)
    v_mfma_f32_32x32x16_bf16 v[32:47], a[232:235], v[232:235], v[32:47]
    v_mul_f32 v94, v80, v82
    v_mul_f32 v95, v84, v86
    v_cvt_pk_bf16_f32 v99, v94, v95
    s_add_u32 s49, s48, 5120
    buffer_store_dwordx4 v[96:99], v2, s[4:7], s49 offen sc1
    v_mfma_f32_32x32x16_bf16 v[32:47], a[236:239], v[236:239], v[32:47]
    s_cmp_lg_u32 s16, 0
    s_cbranch_scc1 L_f_sa_done
    s_mov_b32 s60, 0
    s_waitcnt vmcnt(1)
    s_branch L_f_sa_tst
L_f_sa_chk:
    s_waitcnt vmcnt(0)
L_f_sa_tst:
    v_cmp_eq_u32 vcc, 1, v29
    s_nop 4
    s_cmp_eq_u64 vcc, exec
    s_cbranch_scc1 L_f_sa_done
    buffer_load_dword v29, v28, s[4:7], s57 offen sc1
    s_add_u32 s60, s60, 1
    s_cmp_lt_u32 s60, 0x40000
    s_cbranch_scc1 L_f_sa_chk
    s_waitcnt vmcnt(0)
L_f_sa_done:
    s_barrier
    buffer_load_dwordx4 v[128:131], v2, s[4:7], s78 offen offset:0 sc1
    buffer_load_dwordx4 v[132:135], v2, s[4:7], s82 offen offset:0 sc1
    s_waitcnt lgkmcnt(2)
    v_mfma_f32_32x32x16_bf16 v[32:47], a[240:243], v[240:243], v[32:47]
    buffer_load_dwordx4 v[136:139], v2, s[4:7], s78 offen offset:1024 sc1
    buffer_load_dwordx4 v[140:143], v2, s[4:7], s82 offen offset:1024 sc1
    v_mfma_f32_32x32x16_bf16 v[32:47], a[244:247], v[244:247], v[32:47]
    buffer_load_dwordx4 v[144:147], v2, s[4:7], s78 offen offset:2048 sc1
    buffer_load_dwordx4 v[148:151], v2, s[4:7], s82 offen offset:2048 sc1
    s_waitcnt lgkmcnt(0)
    v_mfma_f32_32x32x16_bf16 v[32:47], a[248:251], v[248:251], v[32:47]
    buffer_load_dwordx4 v[152:155], v2, s[4:7], s79 offen offset:0 sc1
    buffer_load_dwordx4 v[156:159], v2, s[4:7], s83 offen offset:0 sc1
    v_mfma_f32_32x32x16_bf16 v[32:47], a[252:255], v[252:255], v[32:47]
    buffer_load_dwordx4 v[160:163], v2, s[4:7], s79 offen offset:1024 sc1
    buffer_load_dwordx4 v[164:167], v2, s[4:7], s83 offen offset:1024 sc1
    ds_read_b128 v[64:67], v10 offset:768
    ds_read_b128 v[68:71], v10 offset:800
    ds_read_b128 v[72:75], v10 offset:832
    ds_read_b128 v[76:79], v10 offset:864
    s_waitcnt lgkmcnt(3)
    s_nop 4
    v_fma_f32 v80, v122, v64, v32
    v_fma_f32 v84, v122, v65, v33
    s_waitcnt lgkmcnt(1)
    v_fma_f32 v81, v122, v72, v40
    v_fma_f32 v85, v122, v73, v41
    v_mul_f32 v82, v123, v80
    v_mul_f32 v86, v123, v84
    v_exp_f32 v82, v82
    v_exp_f32 v86, v86
    v_mul_f32 v80, v80, v81
    v_mul_f32 v84, v84, v85
    v_add_f32 v82, 1.0, v82
    v_add_f32 v86, 1.0, v86
    v_rcp_f32 v82, v82
    v_rcp_f32 v86, v86
    v_mul_f32 v80, v124, v80
    v_mul_f32 v84, v124, v84
    v_mul_f32 v88, v80, v82
    v_mul_f32 v89, v84, v86
    v_cvt_pk_bf16_f32 v96, v88, v89
    v_fma_f32 v80, v122, v66, v34
    v_fma_f32 v84, v122, v67, v35
    v_fma_f32 v81, v122, v74, v42
    v_fma_f32 v85, v122, v75, v43
    v_mul_f32 v82, v123, v80
    v_mul_f32 v86, v123, v84
    v_exp_f32 v82, v82
    v_exp_f32 v86, v86
    v_mul_f32 v80, v80, v81
    v_mul_f32 v84, v84, v85
    v_add_f32 v82, 1.0, v82
    v_add_f32 v86, 1.0, v86
    v_rcp_f32 v82, v82
    v_rcp_f32 v86, v86
    v_mul_f32 v80, v124, v80
    v_mul_f32 v84, v124, v84
    v_mul_f32 v90, v80, v82
    v_mul_f32 v91, v84, v86
    v_cvt_pk_bf16_f32 v97, v90, v91
    v_fma_f32 v80, v122, v68, v36
    v_fma_f32 v84, v122, v69, v37
    s_waitcnt lgkmcnt(0)
    v_fma_f32 v81, v122, v76, v44
    v_fma_f32 v85, v122, v77, v45
    v_mul_f32 v82, v123, v80
    v_mul_f32 v86, v123, v84
    v_exp_f32 v82, v82
    v_exp_f32 v86, v86
    v_mul_f32 v80, v80, v81
    v_mul_f32 v84, v84, v85
    v_add_f32 v82, 1.0, v82
    v_add_f32 v86, 1.0, v86
    v_rcp_f32 v82, v82
    v_rcp_f32 v86, v86
    v_mul_f32 v80, v124, v80
    v_mul_f32 v84, v124, v84
    v_mul_f32 v92, v80, v82
    v_mul_f32 v93, v84, v86
    v_cvt_pk_bf16_f32 v98, v92, v93
    v_fma_f32 v80, v122, v70, v38
    v_fma_f32 v84, v122, v71, v39
    v_fma_f32 v81, v122, v78, v46
    v_fma_f32 v85, v122, v79, v47
    v_mul_f32 v82, v123, v80
    v_mul_f32 v86, v123, v84
    v_exp_f32 v82, v82
    v_exp_f32 v86, v86
    v_mul_f32 v80, v80, v81
    v_mul_f32 v84, v84, v85
    v_add_f32 v82, 1.0, v82
    v_add_f32 v86, 1.0, v86
    v_rcp_f32 v82, v82
    v_rcp_f32 v86, v86
    v_mul_f32 v80, v124, v80
    v_mul_f32 v84, v124, v84
    v_mul_f32 v94, v80, v82
    v_mul_f32 v95, v84, v86
    v_cvt_pk_bf16_f32 v99, v94, v95
    s_add_u32 s49, s48, 6144
    buffer_store_dwordx4 v[96:99], v2, s[4:7], s49 offen sc1
    s_waitcnt vmcnt(0)
    s_barrier
    s_add_u32 s63, s63, 32768
    s_cmp_lg_u32 s16, 0
    s_cbranch_scc1 L_f_fc_nf
    v_lshlrev_b32 v28, 7, v1
    v_mov_b32 v29, 1
    s_mov_b64 exec, 0xffff
    buffer_store_dword v29, v28, s[4:7], s63 offen sc1
    s_nop 0
    s_mov_b64 exec, -1
L_f_fc_nf:
    buffer_load_dwordx4 v[168:171], v2, s[4:7], s79 offen offset:2048 sc1
    buffer_load_dwordx4 v[172:175], v2, s[4:7], s83 offen offset:2048 sc1
    buffer_load_dwordx4 v[176:179], v2, s[4:7], s80 offen offset:0 sc1
    buffer_load_dwordx4 v[180:183], v2, s[4:7], s84 offen offset:0 sc1
    buffer_load_dwordx4 v[184:187], v2, s[4:7], s80 offen offset:1024 sc1
    buffer_load_dwordx4 v[188:191], v2, s[4:7], s84 offen offset:1024 sc1
    s_add_u32 s57, s57, 32768
    v_mfma_f32_32x32x16_bf16 v[32:47], a[0:3], v[128:131], 0
    v_mfma_f32_32x32x16_bf16 v[48:63], a[0:3], v[132:135], 0
    buffer_load_dwordx4 v[192:195], v2, s[4:7], s80 offen offset:2048 sc1
    v_mfma_f32_32x32x16_bf16 v[64:79], a[4:7], v[128:131], 0
    v_mfma_f32_32x32x16_bf16 v[80:95], a[4:7], v[132:135], 0
    buffer_load_dwordx4 v[196:199], v2, s[4:7], s84 offen offset:2048 sc1
    v_mfma_f32_32x32x16_bf16 v[32:47], a[8:11], v[136:139], v[32:47]
    v_mfma_f32_32x32x16_bf16 v[48:63], a[8:11], v[140:143], v[48:63]
    buffer_load_dwordx4 v[200:203], v2, s[4:7], s81 offen offset:0 sc1
    v_mfma_f32_32x32x16_bf16 v[64:79], a[12:15], v[136:139], v[64:79]
    v_mfma_f32_32x32x16_bf16 v[80:95], a[12:15], v[140:143], v[80:95]
    buffer_load_dwordx4 v[204:207], v2, s[4:7], s85 offen offset:0 sc1
    s_cmp_lg_u32 s16, 0
    s_cbranch_scc1 L_f_pi2
    v_and_b32 v28, 15, v1
    v_lshlrev_b32 v28, 2, v28
    buffer_load_dword v29, v28, s[4:7], s57 offen sc1
L_f_pi2:
    v_mfma_f32_32x32x16_bf16 v[32:47], a[16:19], v[144:147], v[32:47]
    v_mfma_f32_32x32x16_bf16 v[48:63], a[16:19], v[148:151], v[48:63]
    buffer_load_dwordx4 v[128:131], v2, s[4:7], s81 offen offset:1024 sc1
    v_mfma_f32_32x32x16_bf16 v[64:79], a[20:23], v[144:147], v[64:79]
    v_mfma_f32_32x32x16_bf16 v[80:95], a[20:23], v[148:151], v[80:95]
    buffer_load_dwordx4 v[132:135], v2, s[4:7], s85 offen offset:1024 sc1
    v_mfma_f32_32x32x16_bf16 v[32:47], a[24:27], v[152:155], v[32:47]
    v_mfma_f32_32x32x16_bf16 v[48:63], a[24:27], v[156:159], v[48:63]
    buffer_load_dwordx4 v[136:139], v2, s[4:7], s81 offen offset:2048 sc1
    v_mfma_f32_32x32x16_bf16 v[64:79], a[28:31], v[152:155], v[64:79]
    v_mfma_f32_32x32x16_bf16 v[80:95], a[28:31], v[156:159], v[80:95]
    buffer_load_dwordx4 v[140:143], v2, s[4:7], s85 offen offset:2048 sc1
    s_cmp_lg_u32 s16, 0
    s_cbranch_scc1 L_f_s12_done
    s_mov_b32 s60, 0
    s_waitcnt vmcnt(4)
    s_branch L_f_s12_tst
L_f_s12_chk:
    s_waitcnt vmcnt(0)
L_f_s12_tst:
    v_cmp_eq_u32 vcc, 1, v29
    s_nop 4
    s_cmp_eq_u64 vcc, exec
    s_cbranch_scc1 L_f_s12_done
    buffer_load_dword v29, v28, s[4:7], s57 offen sc1
    s_add_u32 s60, s60, 1
    s_cmp_lt_u32 s60, 0x40000
    s_cbranch_scc1 L_f_s12_chk
    s_waitcnt vmcnt(0)
L_f_s12_done:
    s_barrier
    s_add_u32 s57, s57, 32768
    v_mfma_f32_32x32x16_bf16 v[32:47], a[32:35], v[160:163], v[32:47]
    v_mfma_f32_32x32x16_bf16 v[48:63], a[32:35], v[164:167], v[48:63]
    buffer_load_dwordx4 v[144:147], v2, s[4:7], s78 offen offset:3072 sc1
    v_mfma_f32_32x32x16_bf16 v[64:79], a[36:39], v[160:163], v[64:79]
    v_mfma_f32_32x32x16_bf16 v[80:95], a[36:39], v[164:167], v[80:95]
    buffer_load_dwordx4 v[148:151], v2, s[4:7], s82 offen offset:3072 sc1
    s_waitcnt vmcnt(15)
    v_mfma_f32_32x32x16_bf16 v[32:47], a[40:43], v[168:171], v[32:47]
    s_waitcnt vmcnt(14)
    v_mfma_f32_32x32x16_bf16 v[48:63], a[40:43], v[172:175], v[48:63]
    buffer_load_dwordx4 v[152:155], v3, s[4:7], s78 offen offset:0 sc1
    v_mfma_f32_32x32x16_bf16 v[64:79], a[44:47], v[168:171], v[64:79]
    v_mfma_f32_32x32x16_bf16 v[80:95], a[44:47], v[172:175], v[80:95]
    buffer_load_dwordx4 v[156:159], v3, s[4:7], s82 offen offset:0 sc1
    s_waitcnt vmcnt(15)
    v_mfma_f32_32x32x16_bf16 v[32:47], a[48:51], v[176:179], v[32:47]
    s_waitcnt vmcnt(14)
    v_mfma_f32_32x32x16_bf16 v[48:63], a[48:51], v[180:183], v[48:63]
    buffer_load_dwordx4 v[160:163], v2, s[4:7], s79 offen offset:3072 sc1
    v_mfma_f32_32x32x16_bf16 v[64:79], a[52:55], v[176:179], v[64:79]
    v_mfma_f32_32x32x16_bf16 v[80:95], a[52:55], v[180:183], v[80:95]
    buffer_load_dwordx4 v[164:167], v2, s[4:7], s83 offen offset:3072 sc1
    s_waitcnt vmcnt(15)
    v_mfma_f32_32x32x16_bf16 v[32:47], a[56:59], v[184:187], v[32:47]
    s_waitcnt vmcnt(14)
    v_mfma_f32_32x32x16_bf16 v[48:63], a[56:59], v[188:191], v[48:63]
    buffer_load_dwordx4 v[168:171], v3, s[4:7], s79 offen offset:0 sc1
    v_mfma_f32_32x32x16_bf16 v[64:79], a[60:63], v[184:187], v[64:79]
    v_mfma_f32_32x32x16_bf16 v[80:95], a[60:63], v[188:191], v[80:95]
    buffer_load_dwordx4 v[172:175], v3, s[4:7], s83 offen offset:0 sc1
    s_waitcnt vmcnt(15)
    v_mfma_f32_32x32x16_bf16 v[32:47], a[64:67], v[192:195], v[32:47]
    s_waitcnt vmcnt(14)
    v_mfma_f32_32x32x16_bf16 v[48:63], a[64:67], v[196:199], v[48:63]
    buffer_load_dwordx4 v[176:179], v2, s[4:7], s80 offen offset:3072 sc1
    v_mfma_f32_32x32x16_bf16 v[64:79], a[68:71], v[192:195], v[64:79]
    v_mfma_f32_32x32x16_bf16 v[80:95], a[68:71], v[196:199], v[80:95]
    buffer_load_dwordx4 v[180:183], v2, s[4:7], s84 offen offset:3072 sc1
    s_waitcnt vmcnt(15)
    v_mfma_f32_32x32x16_bf16 v[32:47], a[72:75], v[200:203], v[32:47]
    s_waitcnt vmcnt(14)
    v_mfma_f32_32x32x16_bf16 v[48:63], a[72:75], v[204:207], v[48:63]
    buffer_load_dwordx4 v[184:187], v3, s[4:7], s80 offen offset:0 sc1
    v_mfma_f32_32x32x16_bf16 v[64:79], a[76:79], v[200:203], v[64:79]
    v_mfma_f32_32x32x16_bf16 v[80:95], a[76:79], v[204:207], v[80:95]
    buffer_load_dwordx4 v[188:191], v3, s[4:7], s84 offen offset:0 sc1
    s_cmp_lg_u32 s16, 0
    s_cbranch_scc1 L_f_pi3
    v_and_b32 v28, 15, v1
    v_lshlrev_b32 v28, 2, v28
    buffer_load_dword v29, v28, s[4:7], s57 offen sc1
L_f_pi3:
    s_waitcnt vmcnt(15)
    v_mfma_f32_32x32x16_bf16 v[32:47], a[80:83], v[128:131], v[32:47]
    s_waitcnt vmcnt(14)
    v_mfma_f32_32x32x16_bf16 v[48:63], a[80:83], v[132:135], v[48:63]
    buffer_load_dwordx4 v[192:195], v2, s[4:7], s81 offen offset:3072 sc1
    v_mfma_f32_32x32x16_bf16 v[64:79], a[84:87], v[128:131], v[64:79]
    v_mfma_f32_32x32x16_bf16 v[80:95], a[84:87], v[132:135], v[80:95]
    buffer_load_dwordx4 v[196:199], v2, s[4:7], s85 offen offset:3072 sc1
    s_waitcnt vmcnt(15)
    v_mfma_f32_32x32x16_bf16 v[32:47], a[88:91], v[136:139], v[32:47]
    s_waitcnt vmcnt(14)
    v_mfma_f32_32x32x16_bf16 v[48:63], a[88:91], v[140:143], v[48:63]
    buffer_load_dwordx4 v[200:203], v3, s[4:7], s81 offen offset:0 sc1
    v_mfma_f32_32x32x16_bf16 v[64:79], a[92:95], v[136:139], v[64:79]
    v_mfma_f32_32x32x16_bf16 v[80:95], a[92:95], v[140:143], v[80:95]
    buffer_load_dwordx4 v[204:207], v3, s[4:7], s85 offen offset:0 sc1
    s_cmp_lg_u32 s16, 0
    s_cbranch_scc1 L_f_s20_done
    s_mov_b32 s60, 0
    s_waitcnt vmcnt(4)
    s_branch L_f_s20_tst
L_f_s20_chk:
    s_waitcnt vmcnt(0)
L_f_s20_tst:
    v_cmp_eq_u32 vcc, 1, v29
    s_nop 4
    s_cmp_eq_u64 vcc, exec
    s_cbranch_scc1 L_f_s20_done
    buffer_load_dword v29, v28, s[4:7], s57 offen sc1
    s_add_u32 s60, s60, 1
    s_cmp_lt_u32 s60, 0x40000
    s_cbranch_scc1 L_f_s20_chk
    s_waitcnt vmcnt(0)
L_f_s20_done:
    s_barrier
    s_add_u32 s57, s57, 32768
    s_waitcnt vmcnt(15)
    v_mfma_f32_32x32x16_bf16 v[32:47], a[96:99], v[144:147], v[32:47]
    s_waitcnt vmcnt(14)
    v_mfma_f32_32x32x16_bf16 v[48:63], a[96:99], v[148:151], v[48:63]
    buffer_load_dwordx4 v[128:131], v3, s[4:7], s78 offen offset:1024 sc1
    v_mfma_f32_32x32x16_bf16 v[64:79], a[100:103], v[144:147], v[64:79]
    v_mfma_f32_32x32x16_bf16 v[80:95], a[100:103], v[148:151], v[80:95]
    buffer_load_dwordx4 v[132:135], v3, s[4:7], s82 offen offset:1024 sc1
    s_waitcnt vmcnt(15)
    v_mfma_f32_32x32x16_bf16 v[32:47], a[104:107], v[152:155], v[32:47]
    s_waitcnt vmcnt(14)
    v_mfma_f32_32x32x16_bf16 v[48:63], a[104:107], v[156:159], v[48:63]
    buffer_load_dwordx4 v[136:139], v3, s[4:7], s78 offen offset:2048 sc1
    v_mfma_f32_32x32x16_bf16 v[64:79], a[108:111], v[152:155], v[64:79]
    v_mfma_f32_32x32x16_bf16 v[80:95], a[108:111], v[156:159], v[80:95]
    buffer_load_dwordx4 v[140:143], v3, s[4:7], s82 offen offset:2048 sc1
    s_waitcnt vmcnt(15)
    v_mfma_f32_32x32x16_bf16 v[32:47], a[112:115], v[160:163], v[32:47]
    s_waitcnt vmcnt(14)
    v_mfma_f32_32x32x16_bf16 v[48:63], a[112:115], v[164:167], v[48:63]
    buffer_load_dwordx4 v[144:147], v3, s[4:7], s79 offen offset:1024 sc1
    v_mfma_f32_32x32x16_bf16 v[64:79], a[116:119], v[160:163], v[64:79]
    v_mfma_f32_32x32x16_bf16 v[80:95], a[116:119], v[164:167], v[80:95]
    buffer_load_dwordx4 v[148:151], v3, s[4:7], s83 offen offset:1024 sc1
    s_waitcnt vmcnt(15)
    v_mfma_f32_32x32x16_bf16 v[32:47], a[120:123], v[168:171], v[32:47]
    s_waitcnt vmcnt(14)
    v_mfma_f32_32x32x16_bf16 v[48:63], a[120:123], v[172:175], v[48:63]
    buffer_load_dwordx4 v[152:155], v3, s[4:7], s79 offen offset:2048 sc1
    v_mfma_f32_32x32x16_bf16 v[64:79], a[124:127], v[168:171], v[64:79]
    v_mfma_f32_32x32x16_bf16 v[80:95], a[124:127], v[172:175], v[80:95]
    buffer_load_dwordx4 v[156:159], v3, s[4:7], s83 offen offset:2048 sc1
    s_waitcnt vmcnt(15)
    v_mfma_f32_32x32x16_bf16 v[32:47], a[128:131], v[176:179], v[32:47]
    s_waitcnt vmcnt(14)
    v_mfma_f32_32x32x16_bf16 v[48:63], a[128:131], v[180:183], v[48:63]
    buffer_load_dwordx4 v[160:163], v3, s[4:7], s80 offen offset:1024 sc1
    v_mfma_f32_32x32x16_bf16 v[64:79], a[132:135], v[176:179], v[64:79]
    v_mfma_f32_32x32x16_bf16 v[80:95], a[132:135], v[180:183], v[80:95]
    buffer_load_dwordx4 v[164:167], v3, s[4:7], s84 offen offset:1024 sc1
    s_waitcnt vmcnt(15)
    v_mfma_f32_32x32x16_bf16 v[32:47], a[136:139], v[184:187], v[32:47]
    s_waitcnt vmcnt(14)
    v_mfma_f32_32x32x16_bf16 v[48:63], a[136:139], v[188:191], v[48:63]
    buffer_load_dwordx4 v[168:171], v3, s[4:7], s80 offen offset:2048 sc1
    v_mfma_f32_32x32x16_bf16 v[64:79], a[140:143], v[184:187], v[64:79]
    v_mfma_f32_32x32x16_bf16 v[80:95], a[140:143], v[188:191], v[80:95]
    buffer_load_dwordx4 v[172:175], v3, s[4:7], s84 offen offset:2048 sc1
    s_waitcnt vmcnt(15)
    v_mfma_f32_32x32x16_bf16 v[32:47], a[144:147], v[192:195], v[32:47]
    s_waitcnt vmcnt(14)
    v_mfma_f32_32x32x16_bf16 v[48:63], a[144:147], v[196:199], v[48:63]
    buffer_load_dwordx4 v[176:179], v3, s[4:7], s81 offen offset:1024 sc1
    v_mfma_f32_32x32x16_bf16 v[64:79], a[148:151], v[192:195], v[64:79]
    v_mfma_f32_32x32x16_bf16 v[80:95], a[148:151], v[196:199], v[80:95]
    buffer_load_dwordx4 v[180:183], v3, s[4:7], s85 offen offset:1024 sc1
    s_waitcnt vmcnt(15)
    v_mfma_f32_32x32x16_bf16 v[32:47], a[152:155], v[200:203], v[32:47]
    s_waitcnt vmcnt(14)
    v_mfma_f32_32x32x16_bf16 v[48:63], a[152:155], v[204:207], v[48:63]
    buffer_load_dwordx4 v[184:187], v3, s[4:7], s81 offen offset:2048 sc1
    v_mfma_f32_32x32x16_bf16 v[64:79], a[156:159], v[200:203], v[64:79]
    v_mfma_f32_32x32x16_bf16 v[80:95], a[156:159], v[204:207], v[80:95]
    buffer_load_dwordx4 v[188:191], v3, s[4:7], s85 offen offset:2048 sc1
    s_waitcnt vmcnt(15)
    v_mfma_f32_32x32x16_bf16 v[32:47], a[160:163], v[128:131], v[32:47]
    s_waitcnt vmcnt(14)
    v_mfma_f32_32x32x16_bf16 v[48:63], a[160:163], v[132:135], v[48:63]
    v_mfma_f32_32x32x16_bf16 v[64:79], a[164:167], v[128:131], v[64:79]
    v_mfma_f32_32x32x16_bf16 v[80:95], a[164:167], v[132:135], v[80:95]
    s_waitcnt vmcnt(13)
    v_mfma_f32_32x32x16_bf16 v[32:47], a[168:171], v[136:139], v[32:47]
    s_waitcnt vmcnt(12)
    v_mfma_f32_32x32x16_bf16 v[48:63], a[168:171], v[140:143], v[48:63]
    v_mfma_f32_32x32x16_bf16 v[64:79], a[172:175], v[136:139], v[64:79]
    v_mfma_f32_32x32x16_bf16 v[80:95], a[172:175], v[140:143], v[80:95]
    s_waitcnt vmcnt(11)
    v_mfma_f32_32x32x16_bf16 v[32:47], a[176:179], v[144:147], v[32:47]
    s_waitcnt vmcnt(10)
    v_mfma_f32_32x32x16_bf16 v[48:63], a[176:179], v[148:151], v[48:63]
    v_mfma_f32_32x32x16_bf16 v[64:79], a[180:183], v[144:147], v[64:79]
    v_mfma_f32_32x32x16_bf16 v[80:95], a[180:183], v[148:151], v[80:95]
    s_waitcnt vmcnt(9)
    v_mfma_f32_32x32x16_bf16 v[32:47], a[184:187], v[152:155], v[32:47]
    s_waitcnt vmcnt(8)
    v_mfma_f32_32x32x16_bf16 v[48:63], a[184:187], v[156:159], v[48:63]
    v_mfma_f32_32x32x16_bf16 v[64:79], a[188:191], v[152:155], v[64:79]
    v_mfma_f32_32x32x16_bf16 v[80:95], a[188:191], v[156:159], v[80:95]
    s_waitcnt vmcnt(7)
    v_mfma_f32_32x32x16_bf16 v[32:47], a[192:195], v[160:163], v[32:47]
    s_waitcnt vmcnt(6)
    v_mfma_f32_32x32x16_bf16 v[48:63], a[192:195], v[164:167], v[48:63]
    v_mfma_f32_32x32x16_bf16 v[64:79], a[196:199], v[160:163], v[64:79]
    v_mfma_f32_32x32x16_bf16 v[80:95], a[196:199], v[164:167], v[80:95]
    s_waitcnt vmcnt(5)
    v_mfma_f32_32x32x16_bf16 v[32:47], a[200:203], v[168:171], v[32:47]
    s_waitcnt vmcnt(4)
    v_mfma_f32_32x32x16_bf16 v[48:63], a[200:203], v[172:175], v[48:63]
    v_mfma_f32_32x32x16_bf16 v[64:79], a[204:207], v[168:171], v[64:79]
    v_mfma_f32_32x32x16_bf16 v[80:95], a[204:207], v[172:175], v[80:95]
    s_waitcnt vmcnt(3)
    v_mfma_f32_32x32x16_bf16 v[32:47], a[208:211], v[176:179], v[32:47]
    s_waitcnt vmcnt(2)
    v_mfma_f32_32x32x16_bf16 v[48:63], a[208:211], v[180:183], v[48:63]
    v_mfma_f32_32x32x16_bf16 v[64:79], a[212:215], v[176:179], v[64:79]
    v_mfma_f32_32x32x16_bf16 v[80:95], a[212:215], v[180:183], v[80:95]
    s_waitcnt vmcnt(1)
    v_mfma_f32_32x32x16_bf16 v[32:47], a[216:219], v[184:187], v[32:47]
    s_waitcnt vmcnt(0)
    v_mfma_f32_32x32x16_bf16 v[48:63], a[216:219], v[188:191], v[48:63]
    v_mfma_f32_32x32x16_bf16 v[64:79], a[220:223], v[184:187], v[64:79]
    v_mfma_f32_32x32x16_bf16 v[80:95], a[220:223], v[188:191], v[80:95]
    s_mul_i32 s38, s16, 12288
    v_add_u32 v10, s38, v2
    s_nop 7
    ds_write_b128 v10, v[48:51] offset:0
    ds_write_b128 v10, v[52:55] offset:1024
    ds_write_b128 v10, v[56:59] offset:2048
    ds_write_b128 v10, v[60:63] offset:3072
    ds_write_b128 v10, v[64:67] offset:4096
    ds_write_b128 v10, v[68:71] offset:5120
    ds_write_b128 v10, v[72:75] offset:6144
    ds_write_b128 v10, v[76:79] offset:7168
    ds_write_b128 v10, v[80:83] offset:8192
    ds_write_b128 v10, v[84:87] offset:9216
    ds_write_b128 v10, v[88:91] offset:10240
    ds_write_b128 v10, v[92:95] offset:11264
    s_xor_b32 s38, s16, 1
    s_mul_i32 s38, s38, 12288
    s_add_u32 s38, s38, 0
    v_add_u32 v21, s38, v2
    s_xor_b32 s38, s16, 2
    s_mul_i32 s38, s38, 12288
    s_add_u32 s38, s38, 4096
    v_add_u32 v22, s38, v2
    s_xor_b32 s38, s16, 3
    s_mul_i32 s38, s38, 12288
    s_add_u32 s38, s38, 8192
    v_add_u32 v23, s38, v2
    v_lshlrev_b32 v96, 16, v12
    v_and_b32 v97, 0xffff0000, v12
    v_lshlrev_b32 v98, 16, v13
    v_and_b32 v99, 0xffff0000, v13
    v_lshlrev_b32 v100, 16, v14
    v_and_b32 v101, 0xffff0000, v14
    v_lshlrev_b32 v102, 16, v15
    v_and_b32 v103, 0xffff0000, v15
    v_lshlrev_b32 v104, 16, v16
    v_and_b32 v105, 0xffff0000, v16
    v_lshlrev_b32 v106, 16, v17
    v_and_b32 v107, 0xffff0000, v17
    v_lshlrev_b32 v108, 16, v18
    v_and_b32 v109, 0xffff0000, v18
    v_lshlrev_b32 v110, 16, v19
    v_and_b32 v111, 0xffff0000, v19
    v_add_f32 v32, v32, v96
    v_add_f32 v33, v33, v97
    v_add_f32 v34, v34, v98
    v_add_f32 v35, v35, v99
    v_add_f32 v36, v36, v100
    v_add_f32 v37, v37, v101
    v_add_f32 v38, v38, v102
    v_add_f32 v39, v39, v103
    v_add_f32 v40, v40, v104
    v_add_f32 v41, v41, v105
    v_add_f32 v42, v42, v106
    v_add_f32 v43, v43, v107
    v_add_f32 v44, v44, v108
    v_add_f32 v45, v45, v109
    v_add_f32 v46, v46, v110
    v_add_f32 v47, v47, v111
    s_waitcnt lgkmcnt(0)
    s_barrier
    ds_read_b128 v[48:51], v21 offset:0
    ds_read_b128 v[52:55], v21 offset:1024
    ds_read_b128 v[56:59], v21 offset:2048
    ds_read_b128 v[60:63], v21 offset:3072
    ds_read_b128 v[64:67], v22 offset:0
    ds_read_b128 v[68:71], v22 offset:1024
    ds_read_b128 v[72:75], v22 offset:2048
    ds_read_b128 v[76:79], v22 offset:3072
    ds_read_b128 v[80:83], v23 offset:0
    ds_read_b128 v[84:87], v23 offset:1024
    ds_read_b128 v[88:91], v23 offset:2048
    ds_read_b128 v[92:95], v23 offset:3072
    s_waitcnt lgkmcnt(11)
    v_add_f32 v32, v32, v48
    v_add_f32 v33, v33, v49
    v_add_f32 v34, v34, v50
    v_add_f32 v35, v35, v51
    s_waitcnt lgkmcnt(10)
    v_add_f32 v36, v36, v52
    v_add_f32 v37, v37, v53
    v_add_f32 v38, v38, v54
    v_add_f32 v39, v39, v55
    s_waitcnt lgkmcnt(9)
    v_add_f32 v40, v40, v56
    v_add_f32 v41, v41, v57
    v_add_f32 v42, v42, v58
    v_add_f32 v43, v43, v59
    s_waitcnt lgkmcnt(8)
    v_add_f32 v44, v44, v60
    v_add_f32 v45, v45, v61
    v_add_f32 v46, v46, v62
    v_add_f32 v47, v47, v63
    s_waitcnt lgkmcnt(3)
    v_add_f32 v64, v64, v80
    v_add_f32 v65, v65, v81
    v_add_f32 v66, v66, v82
    v_add_f32 v67, v67, v83
    s_waitcnt lgkmcnt(2)
    v_add_f32 v68, v68, v84
    v_add_f32 v69, v69, v85
    v_add_f32 v70, v70, v86
    v_add_f32 v71, v71, v87
    s_waitcnt lgkmcnt(1)
    v_add_f32 v72, v72, v88
    v_add_f32 v73, v73, v89
    v_add_f32 v74, v74, v90
    v_add_f32 v75, v75, v91
    s_waitcnt lgkmcnt(0)
    v_add_f32 v76, v76, v92
    v_add_f32 v77, v77, v93
    v_add_f32 v78, v78, v94
    v_add_f32 v79, v79, v95
    v_add_f32 v32, v32, v64
    v_add_f32 v33, v33, v65
    v_add_f32 v34, v34, v66
    v_add_f32 v35, v35, v67
    v_add_f32 v36, v36, v68
    v_add_f32 v37, v37, v69
    v_add_f32 v38, v38, v70
    v_add_f32 v39, v39, v71
    v_add_f32 v40, v40, v72
    v_add_f32 v41, v41, v73
    v_add_f32 v42, v42, v74
    v_add_f32 v43, v43, v75
    v_add_f32 v44, v44, v76
    v_add_f32 v45, v45, v77
    v_add_f32 v46, v46, v78
    v_add_f32 v47, v47, v79
    v_cvt_pk_bf16_f32 v96, v32, v33
    v_cvt_pk_bf16_f32 v97, v34, v35
    v_cvt_pk_bf16_f32 v98, v36, v37
    v_cvt_pk_bf16_f32 v99, v38, v39
    v_cvt_pk_bf16_f32 v100, v40, v41
    v_cvt_pk_bf16_f32 v101, v42, v43
    v_cvt_pk_bf16_f32 v102, v44, v45
    v_cvt_pk_bf16_f32 v103, v46, v47
    v_permlane32_swap_b32 v96, v98
    v_permlane32_swap_b32 v97, v99
    v_permlane32_swap_b32 v100, v102
    v_permlane32_swap_b32 v101, v103
    v_lshlrev_b32 v8, 10, v4
    v_lshlrev_b32 v9, 4, v6
    v_add_u32 v8, v8, v9
    buffer_store_dwordx4 v[96:99], v8, s[12:15], s32 offen
    buffer_store_dwordx4 v[100:103], v8, s[12:15], s32 offen offset:32
L_f_end:
    s_endpgm
L_text_end:
    s_endpgm
.section .rodata,"a"
.p2align 6
.amdhsa_kernel qkv_kernel
  .amdhsa_next_free_vgpr 256
  .amdhsa_next_free_sgpr 90
  .amdhsa_accum_offset 240
  .amdhsa_group_segment_fixed_size 0
  .amdhsa_kernarg_size 80
  .amdhsa_user_sgpr_count 2
  .amdhsa_user_sgpr_kernarg_segment_ptr 1
  .amdhsa_system_sgpr_workgroup_id_x 1
  .amdhsa_float_denorm_mode_32 3
.end_amdhsa_kernel
.p2align 6
.amdhsa_kernel bcd_kernel
  .amdhsa_next_free_vgpr 512
  .amdhsa_next_free_sgpr 90
  .amdhsa_accum_offset 256
  .amdhsa_group_segment_fixed_size 0
  .amdhsa_kernarg_size 80
  .amdhsa_user_sgpr_count 2
  .amdhsa_user_sgpr_kernarg_segment_ptr 1
  .amdhsa_system_sgpr_workgroup_id_x 1
  .amdhsa_float_denorm_mode_32 3
.end_amdhsa_kernel
```
